```python
import torch

def _softmax(x, axis=-1):
    return torch.softmax(x, dim=axis)
def _gelu(x):
    return torch.nn.functional.gelu(x, approximate="tanh")
def _silu(x):
    return torch.nn.functional.silu(x)
def _sigmoid(x):
    return torch.sigmoid(x)
def _layernorm(x, axis=-1, eps=1e-5):
    m = x.mean(dim=axis, keepdim=True)
    v = x.var(dim=axis, keepdim=True, unbiased=False)
    return (x - m) / torch.sqrt(v + eps)
def _scatter_add(tgt, idx, src, axis=0):
    return tgt.clone().index_add_(axis, idx, src)
def _segment_sum(src, seg, n):
    out = torch.zeros((n,) + src.shape[1:], dtype=src.dtype)
    return out.index_add_(0, seg, src)
def _pad(x, pw):
    flat = tuple(v for pair in reversed(pw) for v in pair)
    return torch.nn.functional.pad(x, flat)

kernel_name = 'recurrent_scan__sliding_block_cached__geglu_ffn__decode'

def setup_inputs():

    _w = (lambda a: (lambda t: t.to(torch.bfloat16) if t.is_floating_point() else t)(torch.as_tensor(a)))
    def _A_setup():
        B, Sq, D = 4, 1, 576
        Hq, Hkv, Sk, Dh = 32, 16, 8192, 128
        assert Hq % Hkv == 0, (Hq, Hkv)
        return {
            "x": _w((lambda *s: torch.randn(*s, dtype=torch.bfloat16) * 0.05)(B, Sq, D)),
            "k_cache": _w((lambda *s: torch.randn(*s, dtype=torch.bfloat16) * 0.8)(B, Hkv, Sk, Dh)),
            "v_cache": _w((lambda *s: torch.randn(*s, dtype=torch.bfloat16) * 0.2)(B, Hkv, Sk, Dh)),
            "wq": _w((lambda *s: torch.randn(*s, dtype=torch.bfloat16) * 0.8)(D, Hq * Dh) * (D ** -0.5)),
            "wo": _w((lambda *s: torch.randn(*s, dtype=torch.bfloat16) * 0.2)(Hq * Dh, D) * ((Hq * Dh) ** -0.5)),
        }
    _A_in = _A_setup()

    def _B_setup():
        B, S, D, F = 4, 1, 576, 4608
        return {
            "x": _w((lambda *s: torch.randn(*s, dtype=torch.bfloat16) * 0.05)(B, S, D)),
            "w_gate": _w((lambda *s: torch.randn(*s, dtype=torch.bfloat16) * 0.1)(D, F)),
            "w_up": _w((lambda *s: torch.randn(*s, dtype=torch.bfloat16) * 0.1)(D, F)),
            "w_down": _w((lambda *s: torch.randn(*s, dtype=torch.bfloat16) * 0.1)(F, D)),
        }
    _B_in = _B_setup()

    return {
        "A_x": _A_in["x"],
        "A_k_cache": _A_in["k_cache"],
        "A_v_cache": _A_in["v_cache"],
        "A_wq": _A_in["wq"],
        "A_wo": _A_in["wo"],
        "B_x": _B_in["x"],
        "B_w_gate": _B_in["w_gate"],
        "B_w_up": _B_in["w_up"],
        "B_w_down": _B_in["w_down"],
    }

def reference(A_x, A_k_cache, A_v_cache, A_wq, A_wo, B_x, B_w_gate, B_w_up, B_w_down):
    def _A_ref(x, k_cache, v_cache, wq, wo):
        B, Sq, D = x.shape
        Hq, Dh = 32, 128
        Hkv, Sk = k_cache.shape[1], k_cache.shape[2]
        W = min(4096, max(256, Sk // 4))
        rep = Hq // Hkv
        q = (lambda x, *d: x.permute(*d))((x @ wq).reshape(B, Sq, Hq, Dh), 0, 2, 1, 3)
        k = (lambda x, n, axis: torch.repeat_interleave(x, n, dim=axis))(k_cache[:, :, Sk - W:, :], rep, axis=1)
        v = (lambda x, n, axis: torch.repeat_interleave(x, n, dim=axis))(v_cache[:, :, Sk - W:, :], rep, axis=1)
        scores = torch.einsum("bhqd,bhkd->bhqk", q, k) * (Dh ** -0.5)
        p = _softmax(scores, axis=-1)
        o = torch.einsum("bhqk,bhkd->bhqd", p, v)
        return (lambda x, *d: x.permute(*d))(o, 0, 2, 1, 3).reshape(B, Sq, Hq * Dh) @ wo

    def _B_ref(x, w_gate, w_up, w_down):
        return (_gelu(x @ w_gate) * (x @ w_up)) @ w_down

    x = A_x
    xn = _layernorm(x, axis=-1)
    s = _A_ref(xn, A_k_cache, A_v_cache, A_wq, A_wo)
    g = _silu(_B_ref(xn, B_w_gate, B_w_up, B_w_down))
    return x + s * g
```

```asm
; @launch grid=(256,1,1) block=(512,1,1) lds=65152
.amdgcn_target "amdgcn-amd-amdhsa--gfx950"
.text
.globl recurrent_scan__sliding_block_cached__geglu_ffn__decode_kernel
.p2align 8
.type recurrent_scan__sliding_block_cached__geglu_ffn__decode_kernel,@function
recurrent_scan__sliding_block_cached__geglu_ffn__decode_kernel:
s_cmp_ge_u32 s2, 256
s_cbranch_scc1 L_end
s_load_dwordx2 s[4:5], s[0:1], 0
s_load_dwordx2 s[8:9], s[0:1], 8
s_load_dwordx2 s[24:25], s[0:1], 88
s_mov_b32 s37, 8192
s_mov_b32 s18, 4718592
s_cmp_ge_u32 s2, 64
s_cselect_b32 s36, 48, 24
s_cselect_b32 s37, 9216, s37
s_cselect_b32 s18, 5308416, s18
s_cselect_b32 s38, 64, 0
s_cmp_ge_u32 s2, 136
s_cselect_b32 s36, 56, s36
s_cselect_b32 s38, 136, s38
s_load_dwordx2 s[16:17], s[0:1], s36
v_lshrrev_b32 v20, 6, v0
v_and_b32 v1, 63, v0
s_mov_b32 s6, 4608
v_readfirstlane_b32 s3, v20
s_mov_b32 s7, 0x20000
s_mov_b32 s10, 0x8000000
s_mov_b32 s11, 0x20000
s_mov_b32 s19, 0x20000
s_mov_b32 s26, 1212416
s_mov_b32 s27, 0x20000
v_lshrrev_b32 v20, 4, v1
v_bfe_u32 v21, v1, 3, 1
v_lshl_add_u32 v21, v21, 2, v20
v_and_b32 v22, 7, v1
v_lshlrev_b32 v22, 4, v22
v_mul_u32_u24 v6, 1152, v21
v_add_u32 v6, v6, v22
v_lshlrev_b32 v3, 4, v1
v_bfe_u32 v2, v1, 1, 3
v_lshlrev_b32 v2, 8, v2
v_lshl_add_u32 v2, v20, 5, v2
v_and_b32 v22, 1, v1
v_lshl_add_u32 v2, v22, 4, v2
s_cmp_ge_u32 s2, 208
s_cselect_b32 s39, 32, 64
s_cbranch_scc1 L_c_pro
v_and_b32 v22, 7, v1
v_lshlrev_b32 v22, 4, v22
v_mad_u32_u24 v5, v21, s37, v22
s_lshl_b32 s40, s37, 3
v_mad_u32_u24 v4, v21, s40, v22
s_and_b32 s41, s3, 3
s_mul_i32 s41, s41, 1152
v_add_u32 v7, s41, v3
v_mov_b32 v22, 0x100000
v_cmp_gt_u32 vcc, 36, v1
s_nop 1
v_cndmask_b32 v7, v22, v7, vcc
s_sub_u32 s42, s2, s38
s_mov_b32 s38, s2
s_lshl_b32 s42, s42, 7
s_mul_i32 s44, s3, s40
s_lshl_b32 s43, s37, 9
s_add_u32 s43, s43, s44
s_add_u32 s43, s43, s42
s_lshl_b32 s44, s44, 3
s_add_u32 s42, s42, s44
s_waitcnt lgkmcnt(0)
s_setprio 3
s_cmp_ge_u32 s3, 4
s_cbranch_scc1 L_nox
buffer_load_dwordx4 v[128:131], v7, s[4:7], 0 offen
buffer_load_dwordx4 v[132:135], v7, s[4:7], 0 offen offset:576
L_nox:
buffer_load_dwordx4 v[192:195], v4, s[16:19], s42 offen nt
s_add_u32 s42, s42, s37
buffer_load_dwordx4 v[196:199], v4, s[16:19], s42 offen nt
s_add_u32 s42, s42, s37
s_load_dwordx2 s[12:13], s[0:1], 16
s_load_dwordx2 s[20:21], s[0:1], s39
s_load_dwordx2 s[28:29], s[0:1], 72
s_load_dword s48, s[24:25], 0
buffer_load_dwordx4 v[200:203], v4, s[16:19], s42 offen nt
s_add_u32 s42, s42, s37
s_lshr_b32 s44, s2, 1
s_xor_b32 s69, s44, s2
s_and_b32 s69, s69, 1
s_lshl_b32 s69, s69, 2
s_lshr_b32 s45, s2, 3
s_add_u32 s44, s44, s45
s_and_b32 s44, s44, 3
s_add_u32 s69, s69, s44
s_and_b32 s44, s2, 0xf8
s_add_u32 s69, s69, s44
s_lshr_b32 s44, s69, 2
s_lshl_b32 s44, s44, 21
s_and_b32 s45, s69, 3
s_lshr_b32 s46, s69, 2
s_mul_i32 s47, s46, 11
s_lshr_b32 s46, s46, 3
s_xor_b32 s47, s47, s46
s_lshl_b32 s46, s3, 1
s_add_u32 s47, s47, s46
s_add_u32 s47, s47, s45
s_lshl_b32 s45, s45, 17
s_add_u32 s44, s44, s45
s_lshl_b32 s45, s3, 14
s_add_u32 s44, s44, s45
s_add_u32 s41, s44, 0x180000
s_and_b32 s46, s47, 4
s_lshl_b32 s46, s46, 11
v_add_u32 v2, s46, v2
v_add_u32 v253, s46, v3
v_xor_b32 v252, 8192, v2
v_xor_b32 v254, 8192, v253
s_and_b32 s47, s47, 3
s_lshl_b32 s47, s47, 11
s_add_u32 s44, s41, s47
s_xor_b32 s45, s47, 2048
s_add_u32 s45, s45, s41
s_xor_b32 s46, s47, 4096
s_add_u32 s46, s46, s41
s_xor_b32 s47, s47, 6144
s_add_u32 s47, s47, s41
s_cmp_ge_u32 s2, 64
s_cbranch_scc1 L_s1p
buffer_load_dwordx4 v[204:207], v4, s[16:19], s42 offen nt
s_add_u32 s42, s42, s37
buffer_load_dwordx4 v[208:211], v4, s[16:19], s42 offen nt
s_add_u32 s42, s42, s37
buffer_load_dwordx4 v[212:215], v4, s[16:19], s42 offen nt
s_add_u32 s42, s42, s37
buffer_load_dwordx4 v[216:219], v4, s[16:19], s42 offen nt
s_add_u32 s42, s42, s37
buffer_load_dwordx4 v[220:223], v4, s[16:19], s42 offen nt
buffer_load_dwordx4 v[224:227], v5, s[16:19], s43 offen nt
L_s1p:
s_setprio 0
s_cmp_ge_u32 s3, 4
s_cbranch_scc1 L_noln
s_cmp_lt_u32 s2, 64
s_cbranch_scc1 L_lnw
s_waitcnt vmcnt(3)
L_lnw:
s_waitcnt vmcnt(9)
s_mov_b32 s50, 0xffff0000
v_lshlrev_b32 v136, 16, v128
v_and_b32 v137, s50, v128
v_lshlrev_b32 v138, 16, v129
v_and_b32 v139, s50, v129
v_lshlrev_b32 v140, 16, v130
v_and_b32 v141, s50, v130
v_lshlrev_b32 v142, 16, v131
v_and_b32 v143, s50, v131
v_lshlrev_b32 v144, 16, v132
v_and_b32 v145, s50, v132
v_lshlrev_b32 v146, 16, v133
v_and_b32 v147, s50, v133
v_lshlrev_b32 v148, 16, v134
v_and_b32 v149, s50, v134
v_lshlrev_b32 v150, 16, v135
v_and_b32 v151, s50, v135
v_pk_add_f32 v[152:153], v[136:137], v[138:139]
v_pk_add_f32 v[152:153], v[152:153], v[140:141]
v_pk_add_f32 v[152:153], v[152:153], v[142:143]
v_pk_add_f32 v[152:153], v[152:153], v[144:145]
v_pk_add_f32 v[152:153], v[152:153], v[146:147]
v_pk_add_f32 v[152:153], v[152:153], v[148:149]
v_pk_add_f32 v[152:153], v[152:153], v[150:151]
v_add_f32 v152, v152, v153
s_nop 1
v_add_f32_dpp v152, v152, v152 row_ror:8 row_mask:0xf bank_mask:0xf
s_nop 1
v_add_f32_dpp v152, v152, v152 row_ror:4 row_mask:0xf bank_mask:0xf
s_nop 1
v_add_f32_dpp v152, v152, v152 row_ror:2 row_mask:0xf bank_mask:0xf
s_nop 1
v_add_f32_dpp v152, v152, v152 row_ror:1 row_mask:0xf bank_mask:0xf
s_nop 1
v_add_f32_dpp v152, v152, v152 row_bcast:15 row_mask:0xa bank_mask:0xf
s_nop 1
v_add_f32_dpp v152, v152, v152 row_bcast:31 row_mask:0xc bank_mask:0xf
v_mul_f32 v152, 0x3ae38e39, v152
s_nop 0
v_readlane_b32 s52, v152, 63
s_nop 0
s_mov_b32 s53, s52
v_pk_add_f32 v[154:155], v[136:137], s[52:53] neg_lo:[0,1] neg_hi:[0,1]
v_pk_mul_f32 v[152:153], v[154:155], v[154:155]
v_pk_add_f32 v[154:155], v[138:139], s[52:53] neg_lo:[0,1] neg_hi:[0,1]
v_pk_fma_f32 v[152:153], v[154:155], v[154:155], v[152:153]
v_pk_add_f32 v[154:155], v[140:141], s[52:53] neg_lo:[0,1] neg_hi:[0,1]
v_pk_fma_f32 v[152:153], v[154:155], v[154:155], v[152:153]
v_pk_add_f32 v[154:155], v[142:143], s[52:53] neg_lo:[0,1] neg_hi:[0,1]
v_pk_fma_f32 v[152:153], v[154:155], v[154:155], v[152:153]
v_pk_add_f32 v[154:155], v[144:145], s[52:53] neg_lo:[0,1] neg_hi:[0,1]
v_pk_fma_f32 v[152:153], v[154:155], v[154:155], v[152:153]
v_pk_add_f32 v[154:155], v[146:147], s[52:53] neg_lo:[0,1] neg_hi:[0,1]
v_pk_fma_f32 v[152:153], v[154:155], v[154:155], v[152:153]
v_pk_add_f32 v[154:155], v[148:149], s[52:53] neg_lo:[0,1] neg_hi:[0,1]
v_pk_fma_f32 v[152:153], v[154:155], v[154:155], v[152:153]
v_pk_add_f32 v[154:155], v[150:151], s[52:53] neg_lo:[0,1] neg_hi:[0,1]
v_pk_fma_f32 v[152:153], v[154:155], v[154:155], v[152:153]
v_add_f32 v152, v152, v153
v_cndmask_b32 v152, 0, v152, vcc
s_nop 1
v_add_f32_dpp v152, v152, v152 row_ror:8 row_mask:0xf bank_mask:0xf
s_nop 1
v_add_f32_dpp v152, v152, v152 row_ror:4 row_mask:0xf bank_mask:0xf
s_nop 1
v_add_f32_dpp v152, v152, v152 row_ror:2 row_mask:0xf bank_mask:0xf
s_nop 1
v_add_f32_dpp v152, v152, v152 row_ror:1 row_mask:0xf bank_mask:0xf
s_nop 1
v_add_f32_dpp v152, v152, v152 row_bcast:15 row_mask:0xa bank_mask:0xf
s_nop 1
v_add_f32_dpp v152, v152, v152 row_bcast:31 row_mask:0xc bank_mask:0xf
v_mul_f32 v152, 0x3ae38e39, v152
s_nop 0
v_readlane_b32 s54, v152, 63
v_mov_b32 v152, s52
s_nop 0
v_mov_b32 v153, s54
v_cvt_pk_bf16_f32 v152, v152, v153
v_and_b32 v153, s50, v152
v_lshlrev_b32 v154, 16, v152
v_mov_b32 v155, v154
v_add_f32 v153, 0x3727c5ac, v153
v_cvt_pk_bf16_f32 v153, v153, v153
v_and_b32 v153, s50, v153
v_sqrt_f32 v153, v153
s_nop 0
v_cvt_pk_bf16_f32 v153, v153, v153
v_and_b32 v153, s50, v153
v_rcp_f32 v152, v153
s_nop 0
v_mov_b32 v153, v152
v_pk_add_f32 v[136:137], v[136:137], v[154:155] neg_lo:[0,1] neg_hi:[0,1]
v_pk_add_f32 v[138:139], v[138:139], v[154:155] neg_lo:[0,1] neg_hi:[0,1]
v_pk_add_f32 v[140:141], v[140:141], v[154:155] neg_lo:[0,1] neg_hi:[0,1]
v_pk_add_f32 v[142:143], v[142:143], v[154:155] neg_lo:[0,1] neg_hi:[0,1]
v_pk_add_f32 v[144:145], v[144:145], v[154:155] neg_lo:[0,1] neg_hi:[0,1]
v_pk_add_f32 v[146:147], v[146:147], v[154:155] neg_lo:[0,1] neg_hi:[0,1]
v_pk_add_f32 v[148:149], v[148:149], v[154:155] neg_lo:[0,1] neg_hi:[0,1]
v_pk_add_f32 v[150:151], v[150:151], v[154:155] neg_lo:[0,1] neg_hi:[0,1]
v_cvt_pk_bf16_f32 v128, v136, v137
v_cvt_pk_bf16_f32 v129, v138, v139
v_cvt_pk_bf16_f32 v130, v140, v141
v_cvt_pk_bf16_f32 v131, v142, v143
v_cvt_pk_bf16_f32 v132, v144, v145
v_cvt_pk_bf16_f32 v133, v146, v147
v_cvt_pk_bf16_f32 v134, v148, v149
v_cvt_pk_bf16_f32 v135, v150, v151
v_lshlrev_b32 v136, 16, v128
v_and_b32 v137, s50, v128
v_lshlrev_b32 v138, 16, v129
v_and_b32 v139, s50, v129
v_lshlrev_b32 v140, 16, v130
v_and_b32 v141, s50, v130
v_lshlrev_b32 v142, 16, v131
v_and_b32 v143, s50, v131
v_lshlrev_b32 v144, 16, v132
v_and_b32 v145, s50, v132
v_lshlrev_b32 v146, 16, v133
v_and_b32 v147, s50, v133
v_lshlrev_b32 v148, 16, v134
v_and_b32 v149, s50, v134
v_lshlrev_b32 v150, 16, v135
v_and_b32 v151, s50, v135
v_pk_mul_f32 v[136:137], v[136:137], v[152:153]
v_pk_mul_f32 v[138:139], v[138:139], v[152:153]
v_pk_mul_f32 v[140:141], v[140:141], v[152:153]
v_pk_mul_f32 v[142:143], v[142:143], v[152:153]
v_pk_mul_f32 v[144:145], v[144:145], v[152:153]
v_pk_mul_f32 v[146:147], v[146:147], v[152:153]
v_pk_mul_f32 v[148:149], v[148:149], v[152:153]
v_pk_mul_f32 v[150:151], v[150:151], v[152:153]
v_cvt_pk_bf16_f32 v128, v136, v137
v_cvt_pk_bf16_f32 v129, v138, v139
v_cvt_pk_bf16_f32 v130, v140, v141
v_cvt_pk_bf16_f32 v131, v142, v143
v_cvt_pk_bf16_f32 v132, v144, v145
v_cvt_pk_bf16_f32 v133, v146, v147
v_cvt_pk_bf16_f32 v134, v148, v149
v_cvt_pk_bf16_f32 v135, v150, v151
s_and_b32 s41, s3, 3
s_mul_i32 s41, s41, 1168
v_add_u32 v20, s41, v3
s_mov_b32 exec_hi, 0xf
ds_write_b128 v20, v[128:131] offset:0
ds_write_b128 v20, v[132:135] offset:576
s_mov_b64 exec, -1
L_noln:
v_and_b32 v20, 3, v1
v_mul_u32_u24 v20, 1168, v20
v_bfe_u32 v21, v1, 2, 1
v_lshrrev_b32 v22, 4, v1
v_lshl_add_u32 v21, v21, 2, v22
s_lshl_b32 s41, s3, 7
v_lshl_add_u32 v22, v21, 4, v20
v_add_u32 v22, s41, v22
s_lshl_b32 s41, s3, 4
v_lshl_add_u32 v23, v21, 1, v20
v_add_u32 v23, s41, v23
s_waitcnt lgkmcnt(0)
s_not_b32 s41, s48
s_sub_u32 s41, s41, 0x01010101
v_mov_b32 v244, s41
v_mov_b32 v248, s41
s_mul_i32 s41, s3, 1088
v_add_u32 v18, s41, v3
v_and_b32 v29, 0x3c, v1
v_mov_b32 v19, 0
ds_write_b32 v29, v19 offset:13056
s_waitcnt lgkmcnt(0)
s_barrier
ds_read_b128 v[24:27], v22 offset:0
ds_read_u16 v28, v23 offset:1024
s_setprio 3
s_cmp_lt_u32 s2, 64
s_cbranch_scc1 L_noka
buffer_load_dwordx4 v[64:67], v2, s[8:11], s44 offen offset:0 nt
buffer_load_dwordx4 v[68:71], v2, s[8:11], s44 offen offset:128 nt
buffer_load_dwordx4 v[204:207], v4, s[16:19], s42 offen nt
s_add_u32 s42, s42, s37
buffer_load_dwordx4 v[72:75], v2, s[8:11], s45 offen offset:0 nt
buffer_load_dwordx4 v[76:79], v2, s[8:11], s45 offen offset:128 nt
buffer_load_dwordx4 v[208:211], v4, s[16:19], s42 offen nt
s_add_u32 s42, s42, s37
buffer_load_dwordx4 v[80:83], v2, s[8:11], s46 offen offset:0 nt
buffer_load_dwordx4 v[84:87], v2, s[8:11], s46 offen offset:128 nt
buffer_load_dwordx4 v[212:215], v4, s[16:19], s42 offen nt
s_add_u32 s42, s42, s37
buffer_load_dwordx4 v[88:91], v2, s[8:11], s47 offen offset:0 nt
buffer_load_dwordx4 v[216:219], v4, s[16:19], s42 offen nt
s_add_u32 s42, s42, s37
buffer_load_dwordx4 v[92:95], v2, s[8:11], s47 offen offset:128 nt
buffer_load_dwordx4 v[220:223], v4, s[16:19], s42 offen nt
buffer_load_dwordx4 v[96:99], v252, s[8:11], s44 offen offset:0 nt
buffer_load_dwordx4 v[224:227], v5, s[16:19], s43 offen nt
buffer_load_dwordx4 v[100:103], v252, s[8:11], s44 offen offset:128 nt
buffer_load_dwordx4 v[104:107], v252, s[8:11], s45 offen offset:0 nt
buffer_load_dwordx4 v[108:111], v252, s[8:11], s45 offen offset:128 nt
L_noka:
s_setprio 0
s_add_u32 s48, s48, 0x01010101
s_mov_b32 s50, 0xffff0000
s_mov_b32 s51, 0xffffff00
s_mov_b32 s55, 0x05040100
s_mov_b32 s56, 0x07060302
s_mov_b32 s57, 0x0c0c0400
s_mov_b32 s58, 0x04000c0c
s_mov_b32 s14, 0x8000000
s_mov_b32 s15, 0x20000
s_mov_b32 s23, 0x20000
s_mov_b32 s30, 4608
s_mov_b32 s31, 0x20000
s_mov_b32 s32, 0xff00ff00
s_mov_b32 s33, 0xff00ff00
s_and_b32 s41, s48, 0xff
v_mov_b32 v8, s41
s_bfe_u32 s41, s48, 0x80008
v_mov_b32 v9, s41
s_bfe_u32 s41, s48, 0x80010
v_mov_b32 v10, s41
s_lshr_b32 s41, s48, 24
v_mov_b32 v11, s41
v_and_b32 v4, 7, v1
v_mul_u32_u24 v4, 1088, v4
v_bfe_u32 v5, v1, 4, 1
v_lshl_add_u32 v4, v5, 9, v4
v_bfe_u32 v5, v1, 3, 1
v_lshl_add_u32 v4, v5, 7, v4
v_lshrrev_b32 v5, 5, v1
v_lshl_add_u32 v4, v5, 6, v4
s_and_b32 s41, s3, 1
s_lshl_b32 s41, s41, 8
s_lshr_b32 s49, s3, 1
s_lshl_b32 s49, s49, 4
s_add_u32 s41, s41, s49
v_add_u32 v4, s41, v4
v_lshrrev_b32 v5, 3, v1
v_lshlrev_b32 v5, 4, v5
s_mov_b32 s42, 0x01010101
s_mov_b32 s43, 0x01010101
s_waitcnt lgkmcnt(0)
v_cndmask_b32 v128, v24, 0, s[32:33]
v_cndmask_b32 v132, 0, v24, s[32:33]
v_cndmask_b32 v129, v25, 0, s[32:33]
v_cndmask_b32 v133, 0, v25, s[32:33]
v_cndmask_b32 v130, v26, 0, s[32:33]
v_cndmask_b32 v134, 0, v26, s[32:33]
v_cndmask_b32 v131, v27, 0, s[32:33]
v_cndmask_b32 v135, 0, v27, s[32:33]
v_lshlrev_b32 v29, 16, v28
v_cndmask_b32 v136, v28, 0, s[32:33]
v_mov_b32 v137, 0
v_cndmask_b32 v138, 0, v29, s[32:33]
v_mov_b32 v139, 0
v_mov_b32 v140, 0
v_mov_b32 v141, v136
v_mov_b32 v142, 0
v_mov_b32 v143, v138
s_cmp_ge_u32 s2, 64
s_cbranch_scc1 L_s1w
s_waitcnt vmcnt(0)
L_s1w:
s_waitcnt vmcnt(3)
v_mfma_f32_16x16x16_bf16 v[32:35], v[224:225], v[136:137], 0
v_mfma_f32_16x16x16_bf16 v[36:39], v[224:225], v[140:141], 0
v_mfma_f32_16x16x16_bf16 v[40:43], v[226:227], v[136:137], 0
v_mfma_f32_16x16x16_bf16 v[44:47], v[226:227], v[140:141], 0
v_mfma_f32_16x16x16_bf16 v[32:35], v[224:225], v[138:139], v[32:35]
v_mfma_f32_16x16x16_bf16 v[36:39], v[224:225], v[142:143], v[36:39]
v_mfma_f32_16x16x16_bf16 v[40:43], v[226:227], v[138:139], v[40:43]
v_mfma_f32_16x16x16_bf16 v[44:47], v[226:227], v[142:143], v[44:47]
v_perm_b32 v144, v196, v192, s55
v_perm_b32 v145, v204, v200, s55
v_perm_b32 v146, v212, v208, s55
v_perm_b32 v147, v220, v216, s55
v_perm_b32 v152, v197, v193, s55
v_perm_b32 v153, v205, v201, s55
v_perm_b32 v154, v213, v209, s55
v_perm_b32 v155, v221, v217, s55
v_mfma_f32_16x16x32_bf16 v[32:35], v[144:147], v[128:131], v[32:35]
v_perm_b32 v160, v198, v194, s55
v_perm_b32 v161, v206, v202, s55
v_perm_b32 v162, v214, v210, s55
v_perm_b32 v163, v222, v218, s55
v_mfma_f32_16x16x32_bf16 v[36:39], v[152:155], v[128:131], v[36:39]
v_perm_b32 v168, v199, v195, s55
v_perm_b32 v169, v207, v203, s55
v_perm_b32 v170, v215, v211, s55
v_perm_b32 v171, v223, v219, s55
v_mfma_f32_16x16x32_bf16 v[40:43], v[160:163], v[128:131], v[40:43]
v_perm_b32 v148, v196, v192, s56
v_perm_b32 v149, v204, v200, s56
v_perm_b32 v150, v212, v208, s56
v_perm_b32 v151, v220, v216, s56
v_mfma_f32_16x16x32_bf16 v[44:47], v[168:171], v[128:131], v[44:47]
v_perm_b32 v156, v197, v193, s56
v_perm_b32 v157, v205, v201, s56
v_perm_b32 v158, v213, v209, s56
v_perm_b32 v159, v221, v217, s56
v_mfma_f32_16x16x32_bf16 v[32:35], v[148:151], v[132:135], v[32:35]
v_perm_b32 v164, v198, v194, s56
v_perm_b32 v165, v206, v202, s56
v_perm_b32 v166, v214, v210, s56
v_perm_b32 v167, v222, v218, s56
v_mfma_f32_16x16x32_bf16 v[36:39], v[156:159], v[132:135], v[36:39]
v_perm_b32 v172, v199, v195, s56
v_perm_b32 v173, v207, v203, s56
v_perm_b32 v174, v215, v211, s56
v_perm_b32 v175, v223, v219, s56
v_mfma_f32_16x16x32_bf16 v[40:43], v[164:167], v[132:135], v[40:43]
s_nop 0
v_mfma_f32_16x16x32_bf16 v[44:47], v[172:175], v[132:135], v[44:47]
s_lshl_b32 s41, s3, 2
v_mov_b32 v21, s41
v_mov_b32 v22, 1
v_permlane32_swap_b32 v32, v36
v_permlane32_swap_b32 v33, v37
v_permlane32_swap_b32 v34, v38
v_permlane32_swap_b32 v35, v39
s_nop 0
v_permlane32_swap_b32 v40, v44
v_permlane32_swap_b32 v41, v45
v_permlane32_swap_b32 v42, v46
v_permlane32_swap_b32 v43, v47
v_add_f32_dpp v32, v36, v32 row_shl:4 row_mask:0xf bank_mask:0x5
v_add_f32_dpp v33, v37, v33 row_shl:4 row_mask:0xf bank_mask:0x5
v_add_f32_dpp v34, v38, v34 row_shl:4 row_mask:0xf bank_mask:0x5
v_add_f32_dpp v35, v39, v35 row_shl:4 row_mask:0xf bank_mask:0x5
v_add_f32_dpp v32, v40, v44 row_shr:4 row_mask:0xf bank_mask:0xa
v_add_f32_dpp v33, v41, v45 row_shr:4 row_mask:0xf bank_mask:0xa
v_add_f32_dpp v34, v42, v46 row_shr:4 row_mask:0xf bank_mask:0xa
v_add_f32_dpp v35, v43, v47 row_shr:4 row_mask:0xf bank_mask:0xa
ds_write_b128 v18, v[32:35] offset:21888
ds_write_b32 v21, v22 offset:13056
s_setprio 3
s_cmp_ge_u32 s2, 64
s_cbranch_scc1 L_kb
s_waitcnt lgkmcnt(0)
s_barrier
ds_read_b128 v[32:35], v4 offset:21888
s_lshl_b32 s41, s38, 3
s_add_u32 s41, s41, s3
s_lshl_b32 s41, s41, 7
s_add_u32 s41, s41, 4096
s_waitcnt lgkmcnt(0)
v_add_f32_dpp v32, v32, v32 quad_perm:[1,0,3,2] row_mask:0xf bank_mask:0xf
v_add_f32_dpp v33, v33, v33 quad_perm:[1,0,3,2] row_mask:0xf bank_mask:0xf
v_add_f32_dpp v34, v34, v34 quad_perm:[1,0,3,2] row_mask:0xf bank_mask:0xf
v_add_f32_dpp v35, v35, v35 quad_perm:[1,0,3,2] row_mask:0xf bank_mask:0xf
v_add_f32_dpp v32, v32, v32 quad_perm:[2,3,0,1] row_mask:0xf bank_mask:0xf
v_add_f32_dpp v33, v33, v33 quad_perm:[2,3,0,1] row_mask:0xf bank_mask:0xf
v_add_f32_dpp v34, v34, v34 quad_perm:[2,3,0,1] row_mask:0xf bank_mask:0xf
v_add_f32_dpp v35, v35, v35 quad_perm:[2,3,0,1] row_mask:0xf bank_mask:0xf
v_add_f32_dpp v32, v32, v32 row_half_mirror row_mask:0xf bank_mask:0xf
v_add_f32_dpp v33, v33, v33 row_half_mirror row_mask:0xf bank_mask:0xf
v_add_f32_dpp v34, v34, v34 row_half_mirror row_mask:0xf bank_mask:0xf
v_add_f32_dpp v35, v35, v35 row_half_mirror row_mask:0xf bank_mask:0xf
v_cvt_pk_bf16_f32 v33, v32, v33
v_cvt_pk_bf16_f32 v35, v34, v35
v_lshl_or_b32 v32, v33, 16, v8
v_and_or_b32 v33, v33, s50, v9
v_lshl_or_b32 v34, v35, 16, v10
v_and_or_b32 v35, v35, s50, v11
s_mov_b64 exec, s[42:43]
buffer_store_dwordx4 v[32:35], v5, s[24:27], s41 offen sc1
s_mov_b64 exec, -1
s_barrier
buffer_load_dwordx4 v[64:67], v2, s[8:11], s44 offen offset:0 nt
buffer_load_dwordx4 v[68:71], v2, s[8:11], s44 offen offset:128 nt
buffer_load_dwordx4 v[72:75], v2, s[8:11], s45 offen offset:0 nt
buffer_load_dwordx4 v[76:79], v2, s[8:11], s45 offen offset:128 nt
buffer_load_dwordx4 v[80:83], v2, s[8:11], s46 offen offset:0 nt
buffer_load_dwordx4 v[84:87], v2, s[8:11], s46 offen offset:128 nt
buffer_load_dwordx4 v[88:91], v2, s[8:11], s47 offen offset:0 nt
buffer_load_dwordx4 v[92:95], v2, s[8:11], s47 offen offset:128 nt
buffer_load_dwordx4 v[96:99], v252, s[8:11], s44 offen offset:0 nt
buffer_load_dwordx4 v[100:103], v252, s[8:11], s44 offen offset:128 nt
buffer_load_dwordx4 v[104:107], v252, s[8:11], s45 offen offset:0 nt
buffer_load_dwordx4 v[108:111], v252, s[8:11], s45 offen offset:128 nt
s_branch L_kb
L_c_pro:
s_lshr_b32 s44, s2, 1
s_xor_b32 s69, s44, s2
s_and_b32 s69, s69, 1
s_lshl_b32 s69, s69, 2
s_lshr_b32 s45, s2, 3
s_add_u32 s44, s44, s45
s_and_b32 s44, s44, 3
s_add_u32 s69, s69, s44
s_and_b32 s44, s2, 0xf8
s_add_u32 s69, s69, s44
s_lshr_b32 s44, s69, 2
s_lshl_b32 s44, s44, 21
s_and_b32 s45, s69, 3
s_lshr_b32 s46, s69, 2
s_mul_i32 s47, s46, 11
s_lshr_b32 s46, s46, 3
s_xor_b32 s47, s47, s46
s_lshl_b32 s46, s3, 1
s_add_u32 s47, s47, s46
s_add_u32 s47, s47, s45
s_lshl_b32 s45, s45, 17
s_add_u32 s44, s44, s45
s_lshl_b32 s45, s3, 14
s_add_u32 s44, s44, s45
s_add_u32 s41, s44, 0x180000
s_and_b32 s46, s47, 4
s_lshl_b32 s46, s46, 11
v_add_u32 v2, s46, v2
v_add_u32 v253, s46, v3
v_xor_b32 v252, 8192, v2
v_xor_b32 v254, 8192, v253
s_and_b32 s47, s47, 3
s_lshl_b32 s47, s47, 11
s_add_u32 s44, s41, s47
s_xor_b32 s45, s47, 2048
s_add_u32 s45, s45, s41
s_xor_b32 s46, s47, 4096
s_add_u32 s46, s46, s41
s_xor_b32 s47, s47, 6144
s_add_u32 s47, s47, s41
s_waitcnt lgkmcnt(0)
L_c_start:
s_setprio 3
buffer_load_dwordx4 v[64:67], v2, s[8:11], s44 offen offset:0 nt
buffer_load_dwordx4 v[68:71], v2, s[8:11], s44 offen offset:128 nt
s_load_dwordx2 s[12:13], s[0:1], 16
s_load_dwordx2 s[20:21], s[0:1], s39
s_load_dwordx2 s[28:29], s[0:1], 72
s_load_dword s48, s[24:25], 0
s_getpc_b64 s[52:53]
L_pc0:
s_sub_u32 s52, s52, L_pc0 - recurrent_scan__sliding_block_cached__geglu_ffn__decode_kernel
s_subb_u32 s53, s53, 0
s_mov_b32 s54, L_codeend - recurrent_scan__sliding_block_cached__geglu_ffn__decode_kernel
s_mov_b32 s55, 0x20000
s_lshl_b32 s41, s3, 11
buffer_load_dwordx4 v[240:243], v3, s[52:55], s41 offen
buffer_load_dwordx4 v[240:243], v3, s[52:55], s41 offen offset:1024
s_waitcnt lgkmcnt(0)
s_not_b32 s41, s48
s_sub_u32 s41, s41, 0x01010101
v_mov_b32 v244, s41
v_mov_b32 v248, s41
s_mul_i32 s41, s3, 1088
v_add_u32 v18, s41, v3
v_and_b32 v29, 0x3c, v1
v_mov_b32 v19, 0
ds_write_b32 v29, v19 offset:13056
s_waitcnt lgkmcnt(0)
s_barrier
buffer_load_dwordx4 v[72:75], v2, s[8:11], s45 offen offset:0 nt
buffer_load_dwordx4 v[76:79], v2, s[8:11], s45 offen offset:128 nt
buffer_load_dwordx4 v[80:83], v2, s[8:11], s46 offen offset:0 nt
buffer_load_dwordx4 v[84:87], v2, s[8:11], s46 offen offset:128 nt
buffer_load_dwordx4 v[88:91], v2, s[8:11], s47 offen offset:0 nt
buffer_load_dwordx4 v[92:95], v2, s[8:11], s47 offen offset:128 nt
buffer_load_dwordx4 v[96:99], v252, s[8:11], s44 offen offset:0 nt
buffer_load_dwordx4 v[100:103], v252, s[8:11], s44 offen offset:128 nt
buffer_load_dwordx4 v[104:107], v252, s[8:11], s45 offen offset:0 nt
buffer_load_dwordx4 v[108:111], v252, s[8:11], s45 offen offset:128 nt
s_add_u32 s48, s48, 0x01010101
s_mov_b32 s50, 0xffff0000
s_mov_b32 s51, 0xffffff00
s_mov_b32 s55, 0x05040100
s_mov_b32 s56, 0x07060302
s_mov_b32 s57, 0x0c0c0400
s_mov_b32 s58, 0x04000c0c
s_mov_b32 s14, 0x8000000
s_mov_b32 s15, 0x20000
s_mov_b32 s23, 0x20000
s_mov_b32 s30, 4608
s_mov_b32 s31, 0x20000
s_mov_b32 s32, 0xff00ff00
s_mov_b32 s33, 0xff00ff00
s_and_b32 s41, s48, 0xff
v_mov_b32 v8, s41
s_bfe_u32 s41, s48, 0x80008
v_mov_b32 v9, s41
s_bfe_u32 s41, s48, 0x80010
v_mov_b32 v10, s41
s_lshr_b32 s41, s48, 24
v_mov_b32 v11, s41
v_and_b32 v4, 7, v1
v_mul_u32_u24 v4, 1088, v4
v_bfe_u32 v5, v1, 4, 1
v_lshl_add_u32 v4, v5, 9, v4
v_bfe_u32 v5, v1, 3, 1
v_lshl_add_u32 v4, v5, 7, v4
v_lshrrev_b32 v5, 5, v1
v_lshl_add_u32 v4, v5, 6, v4
s_and_b32 s41, s3, 1
s_lshl_b32 s41, s41, 8
s_lshr_b32 s49, s3, 1
s_lshl_b32 s49, s49, 4
s_add_u32 s41, s41, s49
v_add_u32 v4, s41, v4
v_lshrrev_b32 v5, 3, v1
v_lshlrev_b32 v5, 4, v5
s_mov_b32 s42, 0x01010101
s_mov_b32 s43, 0x01010101
L_kb:
buffer_load_dwordx4 v[112:115], v252, s[8:11], s46 offen offset:0 nt
buffer_load_dwordx4 v[116:119], v252, s[8:11], s46 offen offset:128 nt
buffer_load_dwordx4 v[120:123], v252, s[8:11], s47 offen offset:0 nt
buffer_load_dwordx4 v[124:127], v252, s[8:11], s47 offen offset:128 nt
s_cmp_ge_u32 s2, 208
s_cbranch_scc1 L_dec_c
s_sub_u32 s41, s2, 46
s_mul_i32 s62, s41, 57
s_lshr_b32 s62, s62, 9
s_mul_i32 s60, s62, 9
s_sub_u32 s60, s41, s60
s_add_u32 s59, s62, 16
s_cmp_ge_u32 s2, 46
s_cselect_b32 s22, 5308416, 0
s_cselect_b32 s62, s62, 0
s_branch L_dec_j
L_dec_c:
s_sub_u32 s41, s2, 208
s_mul_i32 s62, s41, 43
s_lshr_b32 s62, s62, 7
s_mul_i32 s60, s62, 3
s_sub_u32 s60, s41, s60
s_mul_i32 s60, s60, 3
s_mov_b32 s59, s62
s_mov_b32 s22, 4718592
L_dec_j:
s_lshl_b32 s61, s62, 3
s_add_u32 s61, s61, s3
s_mul_i32 s61, s61, 36864
s_lshl_b32 s41, s60, 7
s_add_u32 s61, s61, s41
s_add_u32 s35, s61, 9216
s_add_u32 s36, s61, 18432
s_add_u32 s37, s61, 27648
v_lshrrev_b32 v16, 4, v1
v_lshlrev_b32 v16, 10, v16
v_and_b32 v20, 15, v1
v_lshl_add_u32 v16, v20, 4, v16
s_bfe_u32 s41, s69, 0x40002
s_lshl_b32 s41, s41, 12
s_lshr_b32 s63, s69, 6
s_lshl_b32 s63, s63, 8
s_add_u32 s63, s63, s41
s_add_u32 s63, s63, 4096
v_lshrrev_b32 v17, 4, v1
v_bfe_u32 v20, v1, 2, 1
v_lshl_add_u32 v17, v20, 2, v17
v_lshlrev_b32 v17, 4, v17
v_and_b32 v20, 3, v1
v_lshl_add_u32 v7, v20, 12, v17
v_lshl_add_u32 v17, v20, 8, v17
v_bfe_u32 v20, v1, 3, 1
v_mul_u32_u24 v20, 73728, v20
v_add_u32 v17, v17, v20
s_lshl_b32 s64, s62, 12
s_lshl_b32 s41, s3, 9
s_and_b32 s41, s41, 0xc00
s_add_u32 s64, s64, s41
s_and_b32 s41, s3, 1
s_lshl_b32 s41, s41, 7
s_add_u32 s64, s64, s41
s_add_u32 s64, s64, 69632
v_lshrrev_b32 v20, 3, v1
v_lshlrev_b32 v20, 6, v20
v_and_b32 v21, 7, v1
v_lshl_add_u32 v20, v21, 1, v20
s_lshl_b32 s41, s3, 9
v_add_u32 v20, s41, v20
v_and_b32 v21, 1, v1
v_lshlrev_b32 v21, 8, v21
v_lshrrev_b32 v22, 4, v1
v_lshl_add_u32 v21, v22, 5, v21
v_bfe_u32 v22, v1, 1, 1
v_lshl_add_u32 v21, v22, 4, v21
v_add_u32 v21, s41, v21
s_mov_b32 s65, 200000
s_cmp_lt_u32 s2, 208
s_cbranch_scc1 L_v_ab
s_setprio 3
buffer_load_dwordx4 v[152:155], v253, s[12:15], s47 offen offset:0 nt
buffer_load_dwordx4 v[156:159], v253, s[12:15], s47 offen offset:1024 nt
buffer_load_dwordx4 v[160:163], v254, s[12:15], s44 offen offset:0 nt
buffer_load_dwordx4 v[164:167], v254, s[12:15], s44 offen offset:1024 nt
buffer_load_dwordx4 v[168:171], v254, s[12:15], s45 offen offset:0 nt
buffer_load_dwordx4 v[172:175], v254, s[12:15], s45 offen offset:1024 nt
buffer_load_dwordx4 v[176:179], v254, s[12:15], s46 offen offset:0 nt
buffer_load_dwordx4 v[180:183], v254, s[12:15], s46 offen offset:1024 nt
buffer_load_dwordx4 v[184:187], v254, s[12:15], s47 offen offset:0 nt
buffer_load_dwordx4 v[188:191], v254, s[12:15], s47 offen offset:1024 nt
L_v_ab:
s_cmp_lt_u32 s3, 4
s_cbranch_scc1 L_np1
buffer_load_dwordx4 v[244:247], v16, s[24:27], s63 offen sc1
L_np1:
s_setprio 2
buffer_load_dwordx4 v[128:131], v253, s[12:15], s44 offen offset:0 nt
buffer_load_dwordx4 v[132:135], v253, s[12:15], s44 offen offset:1024 nt
buffer_load_dwordx4 v[136:139], v253, s[12:15], s45 offen offset:0 nt
buffer_load_dwordx4 v[140:143], v253, s[12:15], s45 offen offset:1024 nt
buffer_load_dwordx4 v[144:147], v253, s[12:15], s46 offen offset:0 nt
buffer_load_dwordx4 v[148:151], v253, s[12:15], s46 offen offset:1024 nt
s_cmp_ge_u32 s3, 4
s_cbranch_scc1 L_np2
buffer_load_dwordx4 v[244:247], v16, s[24:27], s63 offen sc1
s_setprio 1
s_cmp_ge_u32 s2, 208
s_cbranch_scc1 L_oc
buffer_load_dwordx4 v[152:155], v253, s[12:15], s47 offen offset:0 nt
buffer_load_dwordx4 v[156:159], v253, s[12:15], s47 offen offset:1024 nt
buffer_load_dwordx4 v[160:163], v254, s[12:15], s44 offen offset:0 nt
buffer_load_dwordx4 v[164:167], v254, s[12:15], s44 offen offset:1024 nt
s_branch L_oj
L_oc:
buffer_load_dwordx4 v[228:231], v6, s[20:23], s61 offen offset:0 nt
buffer_load_dwordx4 v[232:235], v6, s[20:23], s35 offen offset:0 nt
buffer_load_dwordx4 v[236:239], v6, s[20:23], s36 offen offset:0 nt
buffer_load_dwordx4 v[240:243], v6, s[20:23], s37 offen offset:0 nt
L_oj:
s_setprio 0
s_mov_b64 exec, 0
s_cmp_eq_u32 s3, 0
s_cbranch_scc1 H0
s_cmp_eq_u32 s3, 1
s_cbranch_scc1 H2
s_cmp_eq_u32 s3, 2
s_cbranch_scc1 H4
s_branch H6
L_hret:
s_mov_b64 exec, -1
s_waitcnt vmcnt(4)
s_branch L_qchk
L_qre:
buffer_load_dwordx4 v[244:247], v16, s[24:27], s63 offen sc1
s_setprio 0
s_waitcnt vmcnt(0)
s_branch L_qchk
L_np2:
L_np3:
s_setprio 0
s_waitcnt vmcnt(6)
L_qchk:
v_perm_b32 v22, v245, v244, s57
v_perm_b32 v23, v247, v246, s58
v_or_b32 v22, v22, v23
v_cmp_ne_u32 vcc, s48, v22
s_nop 0
s_cbranch_vccz L_qok
s_sub_u32 s65, s65, 1
s_cbranch_scc0 L_qre
L_qok:
H0:
s_cbranch_execz H1
ds_write_b16_d16_hi v20, v244 offset:4736
ds_write_b16_d16_hi v20, v245 offset:4752
ds_write_b16_d16_hi v20, v246 offset:4768
ds_write_b16_d16_hi v20, v247 offset:4784
ds_read_b128 v[24:27], v21 offset:4736
ds_read_b128 v[28:31], v21 offset:4864
v_bfe_u32 v19, v1, 1, 2
v_lshlrev_b32 v19, 6, v19
v_and_b32 v16, 1, v1
v_lshl_add_u32 v19, v16, 5, v19
v_lshrrev_b32 v16, 4, v1
v_lshl_add_u32 v19, v16, 3, v19
v_bfe_u32 v22, v1, 3, 1
v_lshl_add_u32 v19, v22, 2, v19
s_lshl_b32 s41, s3, 9
v_add_u32 v19, s41, v19
v_lshl_add_u32 v16, v22, 2, v16
v_lshlrev_b32 v16, 6, v16
v_add_u32 v16, s41, v16
v_and_b32 v22, 1, v1
v_lshlrev_b32 v22, 4, v22
v_mov_b32 v23, 0xffff
v_lshlrev_b32 v22, v22, v23
v_bfe_u32 v23, v1, 1, 2
v_cmp_eq_u32 vcc, 0, v23
s_nop 1
v_cndmask_b32 v12, 0, v22, vcc
v_cmp_eq_u32 vcc, 1, v23
s_nop 1
v_cndmask_b32 v13, 0, v22, vcc
v_cmp_eq_u32 vcc, 2, v23
s_nop 1
v_cndmask_b32 v14, 0, v22, vcc
v_cmp_eq_u32 vcc, 3, v23
s_nop 1
v_cndmask_b32 v15, 0, v22, vcc
s_mov_b32 s66, 0x000f000f
s_mov_b32 s67, 0x000f000f
s_waitcnt lgkmcnt(0)
v_cndmask_b32 v32, 0, v24, s[66:67]
v_cndmask_b32 v33, 0, v25, s[66:67]
v_cndmask_b32 v34, 0, v26, s[66:67]
v_cndmask_b32 v35, 0, v27, s[66:67]
v_cndmask_b32 v36, 0, v28, s[66:67]
v_cndmask_b32 v37, 0, v29, s[66:67]
v_cndmask_b32 v38, 0, v30, s[66:67]
v_cndmask_b32 v39, 0, v31, s[66:67]
s_lshl_b64 s[66:67], s[66:67], 4
v_cndmask_b32 v40, 0, v24, s[66:67]
v_cndmask_b32 v41, 0, v25, s[66:67]
v_cndmask_b32 v42, 0, v26, s[66:67]
v_cndmask_b32 v43, 0, v27, s[66:67]
v_cndmask_b32 v44, 0, v28, s[66:67]
v_cndmask_b32 v45, 0, v29, s[66:67]
v_cndmask_b32 v46, 0, v30, s[66:67]
v_cndmask_b32 v47, 0, v31, s[66:67]
s_lshl_b64 s[66:67], s[66:67], 4
v_cndmask_b32 v48, 0, v24, s[66:67]
v_cndmask_b32 v49, 0, v25, s[66:67]
v_cndmask_b32 v50, 0, v26, s[66:67]
v_cndmask_b32 v51, 0, v27, s[66:67]
v_cndmask_b32 v52, 0, v28, s[66:67]
v_cndmask_b32 v53, 0, v29, s[66:67]
v_cndmask_b32 v54, 0, v30, s[66:67]
v_cndmask_b32 v55, 0, v31, s[66:67]
s_lshl_b64 s[66:67], s[66:67], 4
v_cndmask_b32 v56, 0, v24, s[66:67]
v_cndmask_b32 v57, 0, v25, s[66:67]
v_cndmask_b32 v58, 0, v26, s[66:67]
v_cndmask_b32 v59, 0, v27, s[66:67]
v_cndmask_b32 v60, 0, v28, s[66:67]
v_cndmask_b32 v61, 0, v29, s[66:67]
v_cndmask_b32 v62, 0, v30, s[66:67]
v_cndmask_b32 v63, 0, v31, s[66:67]
v_mfma_f32_16x16x32_bf16 v[20:23], v[32:35], v[64:67], 0
v_mfma_f32_16x16x32_bf16 v[24:27], v[32:35], v[96:99], 0
v_mfma_f32_16x16x32_bf16 v[20:23], v[36:39], v[68:71], v[20:23]
v_mfma_f32_16x16x32_bf16 v[24:27], v[36:39], v[100:103], v[24:27]
v_mfma_f32_16x16x32_bf16 v[20:23], v[40:43], v[72:75], v[20:23]
v_mfma_f32_16x16x32_bf16 v[24:27], v[40:43], v[104:107], v[24:27]
v_mfma_f32_16x16x32_bf16 v[20:23], v[44:47], v[76:79], v[20:23]
v_mfma_f32_16x16x32_bf16 v[24:27], v[44:47], v[108:111], v[24:27]
v_mfma_f32_16x16x32_bf16 v[20:23], v[48:51], v[80:83], v[20:23]
v_mfma_f32_16x16x32_bf16 v[24:27], v[48:51], v[112:115], v[24:27]
v_mfma_f32_16x16x32_bf16 v[20:23], v[52:55], v[84:87], v[20:23]
v_mfma_f32_16x16x32_bf16 v[24:27], v[52:55], v[116:119], v[24:27]
v_mfma_f32_16x16x32_bf16 v[20:23], v[56:59], v[88:91], v[20:23]
v_mfma_f32_16x16x32_bf16 v[24:27], v[56:59], v[120:123], v[24:27]
v_mfma_f32_16x16x32_bf16 v[20:23], v[60:63], v[92:95], v[20:23]
v_mfma_f32_16x16x32_bf16 v[24:27], v[60:63], v[124:127], v[24:27]
s_mov_b32 s66, 0xaaaaaaaa
s_mov_b32 s67, 0xaaaaaaaa
s_mov_b32 s41, 0x3db504f3
s_nop 3
v_add_f32_dpp v20, v22, v20 quad_perm:[1,0,3,2] row_mask:0xf bank_mask:0xf
v_add_f32_dpp v21, v23, v21 quad_perm:[1,0,3,2] row_mask:0xf bank_mask:0xf
v_add_f32_dpp v26, v24, v26 quad_perm:[1,0,3,2] row_mask:0xf bank_mask:0xf
v_add_f32_dpp v27, v25, v27 quad_perm:[1,0,3,2] row_mask:0xf bank_mask:0xf
v_cndmask_b32 v20, v20, v26, s[66:67]
v_cndmask_b32 v21, v21, v27, s[66:67]
v_cvt_pk_bf16_f32 v22, v20, v21
v_lshlrev_b32 v20, 16, v22
v_and_b32 v21, s50, v22
v_mul_f32 v20, s41, v20
v_mul_f32 v21, s41, v21
v_cvt_pk_bf16_f32 v22, v20, v21
s_mov_b32 s41, 0x3fb8aa3b
v_lshlrev_b32 v20, 16, v22
v_and_b32 v21, s50, v22
v_mul_f32 v20, s41, v20
v_mul_f32 v21, s41, v21
v_mov_b32 v22, v20
v_mov_b32 v23, v21
s_nop 0
v_max_f32_dpp v22, v22, v22 row_ror:8 row_mask:0xf bank_mask:0xf
v_max_f32_dpp v23, v23, v23 row_ror:8 row_mask:0xf bank_mask:0xf
s_nop 0
v_max_f32_dpp v22, v22, v22 row_ror:4 row_mask:0xf bank_mask:0xf
v_max_f32_dpp v23, v23, v23 row_ror:4 row_mask:0xf bank_mask:0xf
s_nop 0
v_max_f32_dpp v22, v22, v22 row_ror:2 row_mask:0xf bank_mask:0xf
v_max_f32_dpp v23, v23, v23 row_ror:2 row_mask:0xf bank_mask:0xf
s_nop 0
v_max_f32_dpp v22, v22, v22 row_ror:1 row_mask:0xf bank_mask:0xf
v_max_f32_dpp v23, v23, v23 row_ror:1 row_mask:0xf bank_mask:0xf
s_nop 0
v_max_f32_dpp v22, v22, v22 row_bcast:15 row_mask:0xa bank_mask:0xf
v_max_f32_dpp v23, v23, v23 row_bcast:15 row_mask:0xa bank_mask:0xf
s_nop 0
v_max_f32_dpp v22, v22, v22 row_bcast:31 row_mask:0xc bank_mask:0xf
v_max_f32_dpp v23, v23, v23 row_bcast:31 row_mask:0xc bank_mask:0xf
s_lshr_b32 s66, s69, 6
s_bfe_u32 s67, s69, 0x40002
v_readlane_b32 s52, v22, 63
v_readlane_b32 s53, v23, 63
s_lshl_b32 s67, s67, 2
s_add_u32 s66, s66, s67
s_and_b32 s67, s69, 3
s_and_b32 s52, s52, s51
s_and_b32 s53, s53, s51
v_subrev_f32 v20, s52, v20
v_subrev_f32 v21, s53, v21
v_exp_f32 v20, v20
v_exp_f32 v21, v21
v_cvt_pk_bf16_f32 v22, v20, v20
H1:
s_cbranch_execz L_hret
v_cvt_pk_bf16_f32 v23, v21, v21
ds_write_b32 v19, v22 offset:8832
ds_write_b32 v19, v23 offset:9088
v_mov_b32 v30, s52
v_mov_b32 v31, s53
s_lshl_b32 s68, s3, 4
s_lshl_b32 s41, s3, 2
v_mov_b32 v26, s41
v_mov_b32 v27, 1
v_add_f32_dpp v20, v20, v20 row_ror:8 row_mask:0xf bank_mask:0xf
v_add_f32_dpp v21, v21, v21 row_ror:8 row_mask:0xf bank_mask:0xf
s_nop 0
v_add_f32_dpp v20, v20, v20 row_ror:4 row_mask:0xf bank_mask:0xf
v_add_f32_dpp v21, v21, v21 row_ror:4 row_mask:0xf bank_mask:0xf
s_nop 0
v_add_f32_dpp v20, v20, v20 row_ror:2 row_mask:0xf bank_mask:0xf
v_add_f32_dpp v21, v21, v21 row_ror:2 row_mask:0xf bank_mask:0xf
s_nop 0
v_add_f32_dpp v20, v20, v20 row_ror:1 row_mask:0xf bank_mask:0xf
v_add_f32_dpp v21, v21, v21 row_ror:1 row_mask:0xf bank_mask:0xf
s_nop 0
v_add_f32_dpp v20, v20, v20 row_bcast:15 row_mask:0xa bank_mask:0xf
v_add_f32_dpp v21, v21, v21 row_bcast:15 row_mask:0xa bank_mask:0xf
s_nop 0
v_add_f32_dpp v20, v20, v20 row_bcast:31 row_mask:0xc bank_mask:0xf
v_add_f32_dpp v21, v21, v21 row_bcast:31 row_mask:0xc bank_mask:0xf
s_mov_b32 s52, 0xaaaaaaaa
s_mov_b32 s53, 0xaaaaaaaa
v_cndmask_b32 v24, v30, v31, s[52:53]
v_cndmask_b32 v25, v20, v21, s[52:53]
v_and_b32 v22, 1, v1
v_lshl_add_u32 v22, v22, 3, s68
s_mov_b32 exec_lo, 0
s_mov_b32 exec_hi, 0xc0000000
ds_write_b64 v22, v[24:25] offset:12928
ds_write_b32 v26, v27 offset:13088
s_mov_b64 exec, -1
s_setprio 1
s_cmp_ge_u32 s2, 208
s_cbranch_scc1 L_nov2
s_cmp_lt_u32 s2, 64
s_cbranch_scc1 L_nos1b
v_and_b32 v22, 7, v1
v_lshlrev_b32 v22, 2, v22
L_s1chkb:
ds_read_b32 v23, v22 offset:13056
s_waitcnt lgkmcnt(0)
v_cmp_ne_u32 vcc, 1, v23
s_nop 0
s_cbranch_vccz L_s1okb
s_sub_u32 s65, s65, 1
s_cbranch_scc0 L_s1chkb
L_s1okb:
ds_read_b128 v[24:27], v4 offset:21888
s_lshl_b32 s41, s38, 3
s_add_u32 s41, s41, s3
s_lshl_b32 s41, s41, 7
s_add_u32 s41, s41, 4096
s_waitcnt lgkmcnt(0)
v_add_f32_dpp v24, v24, v24 quad_perm:[1,0,3,2] row_mask:0xf bank_mask:0xf
v_add_f32_dpp v25, v25, v25 quad_perm:[1,0,3,2] row_mask:0xf bank_mask:0xf
v_add_f32_dpp v26, v26, v26 quad_perm:[1,0,3,2] row_mask:0xf bank_mask:0xf
v_add_f32_dpp v27, v27, v27 quad_perm:[1,0,3,2] row_mask:0xf bank_mask:0xf
v_add_f32_dpp v24, v24, v24 quad_perm:[2,3,0,1] row_mask:0xf bank_mask:0xf
v_add_f32_dpp v25, v25, v25 quad_perm:[2,3,0,1] row_mask:0xf bank_mask:0xf
v_add_f32_dpp v26, v26, v26 quad_perm:[2,3,0,1] row_mask:0xf bank_mask:0xf
v_add_f32_dpp v27, v27, v27 quad_perm:[2,3,0,1] row_mask:0xf bank_mask:0xf
v_add_f32_dpp v24, v24, v24 row_half_mirror row_mask:0xf bank_mask:0xf
v_add_f32_dpp v25, v25, v25 row_half_mirror row_mask:0xf bank_mask:0xf
v_add_f32_dpp v26, v26, v26 row_half_mirror row_mask:0xf bank_mask:0xf
v_add_f32_dpp v27, v27, v27 row_half_mirror row_mask:0xf bank_mask:0xf
v_cvt_pk_bf16_f32 v25, v24, v25
v_cvt_pk_bf16_f32 v27, v26, v27
v_lshl_or_b32 v24, v25, 16, v8
v_and_or_b32 v25, v25, s50, v9
v_lshl_or_b32 v26, v27, 16, v10
v_and_or_b32 v27, v27, s50, v11
s_mov_b64 exec, s[42:43]
buffer_store_dwordx4 v[24:27], v5, s[24:27], s41 offen sc1
s_mov_b64 exec, -1
L_nos1b:
s_cmp_lt_u32 s3, 4
s_cbranch_scc1 L_vr
buffer_load_dwordx4 v[152:155], v253, s[12:15], s47 offen offset:0 nt
buffer_load_dwordx4 v[156:159], v253, s[12:15], s47 offen offset:1024 nt
buffer_load_dwordx4 v[160:163], v254, s[12:15], s44 offen offset:0 nt
buffer_load_dwordx4 v[164:167], v254, s[12:15], s44 offen offset:1024 nt
L_vr:
buffer_load_dwordx4 v[168:171], v254, s[12:15], s45 offen offset:0 nt
buffer_load_dwordx4 v[172:175], v254, s[12:15], s45 offen offset:1024 nt
buffer_load_dwordx4 v[176:179], v254, s[12:15], s46 offen offset:0 nt
buffer_load_dwordx4 v[180:183], v254, s[12:15], s46 offen offset:1024 nt
buffer_load_dwordx4 v[184:187], v254, s[12:15], s47 offen offset:0 nt
buffer_load_dwordx4 v[188:191], v254, s[12:15], s47 offen offset:1024 nt
s_setprio 0
s_branch L_nov3
L_nov2:
s_setprio 0
s_cmp_lt_u32 s3, 4
s_cbranch_scc1 L_sr
buffer_load_dwordx4 v[228:231], v6, s[20:23], s61 offen offset:0 nt
buffer_load_dwordx4 v[232:235], v6, s[20:23], s35 offen offset:0 nt
buffer_load_dwordx4 v[236:239], v6, s[20:23], s36 offen offset:0 nt
buffer_load_dwordx4 v[240:243], v6, s[20:23], s37 offen offset:0 nt
L_sr:
buffer_load_dwordx4 v[192:195], v6, s[20:23], s61 offen offset:128 nt
buffer_load_dwordx4 v[196:199], v6, s[20:23], s35 offen offset:128 nt
buffer_load_dwordx4 v[200:203], v6, s[20:23], s36 offen offset:128 nt
buffer_load_dwordx4 v[204:207], v6, s[20:23], s37 offen offset:128 nt
buffer_load_dwordx4 v[208:211], v6, s[20:23], s61 offen offset:256 nt
buffer_load_dwordx4 v[212:215], v6, s[20:23], s35 offen offset:256 nt
buffer_load_dwordx4 v[216:219], v6, s[20:23], s36 offen offset:256 nt
buffer_load_dwordx4 v[220:223], v6, s[20:23], s37 offen offset:256 nt
s_waitcnt vmcnt(12)
L_nov3:
s_cmp_lg_u32 s3, 5
s_cbranch_scc1 L_nofac
v_and_b32 v22, 15, v1
v_lshlrev_b32 v22, 3, v22
v_bfe_u32 v23, v1, 1, 3
v_lshlrev_b32 v25, 2, v23
v_and_b32 v24, 1, v1
v_lshl_add_u32 v23, v24, 5, v25
s_lshl_b32 s39, s66, 7
s_lshl_b32 s68, s67, 5
s_add_u32 s39, s39, s68
s_add_u32 s39, s39, 524288
L_stchk:
ds_read_b32 v24, v25 offset:13088
ds_read_b64 v[244:245], v22 offset:12928
s_waitcnt lgkmcnt(0)
v_cmp_ne_u32 vcc, 1, v24
s_nop 0
s_cbranch_vccz L_stok
s_sub_u32 s65, s65, 1
s_cbranch_scc0 L_stchk
L_stok:
v_max_f32_dpp v24, v244, v244 row_ror:8 row_mask:0xf bank_mask:0xf
s_nop 1
v_max_f32_dpp v24, v24, v24 row_ror:4 row_mask:0xf bank_mask:0xf
s_nop 1
v_max_f32_dpp v24, v24, v24 row_ror:2 row_mask:0xf bank_mask:0xf
v_sub_f32 v244, v244, v24
v_exp_f32 v244, v244
s_nop 0
v_mul_f32 v25, v245, v244
s_nop 1
v_add_f32_dpp v25, v25, v25 row_ror:8 row_mask:0xf bank_mask:0xf
s_nop 1
v_add_f32_dpp v25, v25, v25 row_ror:4 row_mask:0xf bank_mask:0xf
s_nop 1
v_add_f32_dpp v25, v25, v25 row_ror:2 row_mask:0xf bank_mask:0xf
s_mov_b64 exec, 0xffff
ds_write_b32 v23, v244 offset:13120
s_mov_b64 exec, -1
v_and_or_b32 v246, v24, s51, v10
v_and_or_b32 v247, v25, s51, v11
v_and_or_b32 v244, v24, s51, v8
v_and_or_b32 v245, v25, s51, v9
L_nofac:
ds_read_b128 v[32:35], v16 offset:8832
ds_read_b128 v[36:39], v16 offset:8848
ds_read_b128 v[40:43], v16 offset:8864
ds_read_b128 v[44:47], v16 offset:8880
s_waitcnt lgkmcnt(0)
s_cmp_ge_u32 s2, 208
v_and_b32 v48, v12, v32
v_and_b32 v49, v13, v32
v_and_b32 v50, v14, v32
v_and_b32 v51, v15, v32
H2:
s_cbranch_execz H3
v_and_b32 v52, v12, v33
v_and_b32 v53, v13, v33
v_and_b32 v54, v14, v33
v_and_b32 v55, v15, v33
s_cbranch_scc1 L_pvw0
s_waitcnt vmcnt(12)
L_pvw0:
v_mfma_f32_16x16x32_bf16 v[60:63], v[128:131], v[48:51], 0
v_and_b32 v56, v12, v34
v_and_b32 v57, v13, v34
v_and_b32 v58, v14, v34
v_and_b32 v59, v15, v34
v_mfma_f32_16x16x32_bf16 v[60:63], v[132:135], v[52:55], v[60:63]
v_and_b32 v48, v12, v35
v_and_b32 v49, v13, v35
v_and_b32 v50, v14, v35
v_and_b32 v51, v15, v35
v_mfma_f32_16x16x32_bf16 v[60:63], v[136:139], v[56:59], v[60:63]
v_and_b32 v52, v12, v36
v_and_b32 v53, v13, v36
v_and_b32 v54, v14, v36
v_and_b32 v55, v15, v36
v_mfma_f32_16x16x32_bf16 v[60:63], v[140:143], v[48:51], v[60:63]
v_and_b32 v56, v12, v37
v_and_b32 v57, v13, v37
v_and_b32 v58, v14, v37
v_and_b32 v59, v15, v37
s_cbranch_scc1 L_pvw4
s_waitcnt vmcnt(8)
L_pvw4:
v_mfma_f32_16x16x32_bf16 v[60:63], v[144:147], v[52:55], v[60:63]
v_and_b32 v48, v12, v38
v_and_b32 v49, v13, v38
v_and_b32 v50, v14, v38
v_and_b32 v51, v15, v38
v_mfma_f32_16x16x32_bf16 v[60:63], v[148:151], v[56:59], v[60:63]
v_and_b32 v52, v12, v39
v_and_b32 v53, v13, v39
v_and_b32 v54, v14, v39
v_and_b32 v55, v15, v39
v_mfma_f32_16x16x32_bf16 v[60:63], v[152:155], v[48:51], v[60:63]
v_and_b32 v56, v12, v40
v_and_b32 v57, v13, v40
v_and_b32 v58, v14, v40
v_and_b32 v59, v15, v40
v_mfma_f32_16x16x32_bf16 v[60:63], v[156:159], v[52:55], v[60:63]
v_and_b32 v48, v12, v41
v_and_b32 v49, v13, v41
v_and_b32 v50, v14, v41
v_and_b32 v51, v15, v41
s_cbranch_scc1 L_pvw8
s_waitcnt vmcnt(6)
L_pvw8:
v_mfma_f32_16x16x32_bf16 v[60:63], v[160:163], v[56:59], v[60:63]
v_and_b32 v52, v12, v42
v_and_b32 v53, v13, v42
v_and_b32 v54, v14, v42
v_and_b32 v55, v15, v42
v_mfma_f32_16x16x32_bf16 v[60:63], v[164:167], v[48:51], v[60:63]
v_and_b32 v56, v12, v43
v_and_b32 v57, v13, v43
v_and_b32 v58, v14, v43
v_and_b32 v59, v15, v43
s_cbranch_scc1 L_pvw10
s_waitcnt vmcnt(4)
L_pvw10:
v_mfma_f32_16x16x32_bf16 v[60:63], v[168:171], v[52:55], v[60:63]
v_and_b32 v48, v12, v44
v_and_b32 v49, v13, v44
v_and_b32 v50, v14, v44
v_and_b32 v51, v15, v44
v_mfma_f32_16x16x32_bf16 v[60:63], v[172:175], v[56:59], v[60:63]
v_and_b32 v52, v12, v45
v_and_b32 v53, v13, v45
v_and_b32 v54, v14, v45
v_and_b32 v55, v15, v45
s_cbranch_scc1 L_pvw12
s_waitcnt vmcnt(2)
L_pvw12:
v_mfma_f32_16x16x32_bf16 v[60:63], v[176:179], v[48:51], v[60:63]
v_and_b32 v56, v12, v46
v_and_b32 v57, v13, v46
v_and_b32 v58, v14, v46
v_and_b32 v59, v15, v46
v_mfma_f32_16x16x32_bf16 v[60:63], v[180:183], v[52:55], v[60:63]
v_and_b32 v48, v12, v47
v_and_b32 v49, v13, v47
v_and_b32 v50, v14, v47
v_and_b32 v51, v15, v47
s_cbranch_scc1 L_pvw14
s_waitcnt vmcnt(1)
L_pvw14:
v_mfma_f32_16x16x32_bf16 v[60:63], v[184:187], v[56:59], v[60:63]
s_cbranch_scc1 L_pvw15
s_waitcnt vmcnt(0)
L_pvw15:
v_mfma_f32_16x16x32_bf16 v[60:63], v[188:191], v[48:51], v[60:63]
L_or:
v_and_b32 v25, 7, v1
v_mul_u32_u24 v26, 1088, v25
v_add_u32 v26, v26, v5
s_lshl_b32 s41, s3, 7
v_add_u32 v26, s41, v26
s_and_b32 s41, s3, 1
s_lshl_b32 s68, s41, 5
v_lshl_add_u32 v25, v25, 2, s68
ds_write_b128 v18, v[60:63] offset:13184
s_lshl_b32 s41, s41, 11
s_lshr_b32 s68, s3, 1
s_lshl_b32 s68, s68, 7
s_add_u32 s41, s41, s68
s_lshl_b32 s68, s66, 12
s_add_u32 s41, s41, s68
s_lshl_b32 s68, s67, 9
s_add_u32 s41, s41, s68
s_add_u32 s41, s41, 262144
s_cmp_lg_u32 s3, 5
s_cbranch_scc1 L_nost
s_mov_b64 exec, 3
buffer_store_dwordx4 v[244:247], v3, s[24:27], s39 offen sc1
s_mov_b64 exec, -1
L_nost:
s_waitcnt lgkmcnt(0)
s_barrier
ds_read_b32 v36, v25 offset:13120
ds_read_b128 v[32:35], v26 offset:13184
s_waitcnt lgkmcnt(0)
v_mul_f32 v32, v32, v36
v_mul_f32 v33, v33, v36
v_mul_f32 v34, v34, v36
v_mul_f32 v35, v35, v36
v_add_f32_dpp v32, v32, v32 quad_perm:[1,0,3,2] row_mask:0xf bank_mask:0xf
v_add_f32_dpp v33, v33, v33 quad_perm:[1,0,3,2] row_mask:0xf bank_mask:0xf
v_add_f32_dpp v34, v34, v34 quad_perm:[1,0,3,2] row_mask:0xf bank_mask:0xf
v_add_f32_dpp v35, v35, v35 quad_perm:[1,0,3,2] row_mask:0xf bank_mask:0xf
v_add_f32_dpp v32, v32, v32 quad_perm:[2,3,0,1] row_mask:0xf bank_mask:0xf
v_add_f32_dpp v33, v33, v33 quad_perm:[2,3,0,1] row_mask:0xf bank_mask:0xf
v_add_f32_dpp v34, v34, v34 quad_perm:[2,3,0,1] row_mask:0xf bank_mask:0xf
v_add_f32_dpp v35, v35, v35 quad_perm:[2,3,0,1] row_mask:0xf bank_mask:0xf
v_add_f32_dpp v32, v32, v32 row_half_mirror row_mask:0xf bank_mask:0xf
v_add_f32_dpp v33, v33, v33 row_half_mirror row_mask:0xf bank_mask:0xf
v_add_f32_dpp v34, v34, v34 row_half_mirror row_mask:0xf bank_mask:0xf
v_add_f32_dpp v35, v35, v35 row_half_mirror row_mask:0xf bank_mask:0xf
v_and_or_b32 v32, v32, s51, v8
v_and_or_b32 v33, v33, s51, v9
v_and_or_b32 v34, v34, s51, v10
v_and_or_b32 v35, v35, s51, v11
s_mov_b64 exec, s[42:43]
buffer_store_dwordx4 v[32:35], v5, s[24:27], s41 offen sc1
s_mov_b64 exec, -1
s_setprio 0
L_s3go:
s_cmp_lt_u32 s2, 46
s_cbranch_scc1 L_final
v_and_b32 v28, 3, v1
v_mul_u32_u24 v28, 147456, v28
v_bfe_u32 v21, v1, 4, 1
H3:
s_cbranch_execz L_hret
v_lshl_add_u32 v28, v21, 13, v28
v_bfe_u32 v21, v1, 2, 1
v_lshl_add_u32 v28, v21, 6, v28
v_lshrrev_b32 v21, 5, v1
v_lshl_add_u32 v28, v21, 5, v28
v_bfe_u32 v21, v1, 3, 1
v_lshl_add_u32 v28, v21, 4, v28
s_add_u32 s40, s60, s3
s_lshl_b32 s40, s40, 14
s_lshl_b32 s66, s59, 7
s_add_u32 s40, s40, s66
s_add_u32 s40, s40, 589824
s_mul_i32 s66, s3, 8704
v_add_u32 v29, s66, v3
s_cmp_ge_u32 s2, 208
s_cbranch_scc1 L_ctail
s_barrier
buffer_load_dwordx4 v[248:251], v17, s[24:27], s64 offen sc1
buffer_load_dwordx4 v[228:231], v6, s[20:23], s61 offen offset:0 nt
buffer_load_dwordx4 v[232:235], v6, s[20:23], s35 offen offset:0 nt
buffer_load_dwordx4 v[236:239], v6, s[20:23], s36 offen offset:0 nt
buffer_load_dwordx4 v[240:243], v6, s[20:23], s37 offen offset:0 nt
s_waitcnt vmcnt(4)
L_guchk:
v_perm_b32 v22, v249, v248, s57
v_perm_b32 v23, v251, v250, s58
v_or_b32 v22, v22, v23
v_cmp_ne_u32 vcc, s48, v22
s_nop 0
s_cbranch_vccz L_guok
s_sub_u32 s65, s65, 1
s_cbranch_scc1 L_guok
buffer_load_dwordx4 v[248:251], v17, s[24:27], s64 offen sc1
s_waitcnt vmcnt(0)
s_branch L_guchk
L_guok:
s_mov_b32 s41, 0x3dd2d3e8
v_mov_b32 v40, 0x40135761
v_and_b32 v32, s50, v248
v_and_b32 v33, s50, v249
v_and_b32 v34, s50, v250
v_and_b32 v35, s50, v251
v_mov_b32 v38, v32
v_mov_b32 v39, v33
v_mov_b32_dpp v32, v34 row_ror:8 row_mask:0xf bank_mask:0xc
v_mov_b32_dpp v33, v35 row_ror:8 row_mask:0xf bank_mask:0xc
v_mov_b32_dpp v34, v38 row_ror:8 row_mask:0xf bank_mask:0x3
v_mov_b32_dpp v35, v39 row_ror:8 row_mask:0xf bank_mask:0x3
v_mul_f32 v36, v32, v32
v_mul_f32 v37, v33, v33
v_fma_f32 v36, v36, s41, v40
v_fma_f32 v37, v37, s41, v40
v_mul_f32 v36, v36, v32
v_mul_f32 v37, v37, v33
v_exp_f32 v36, -v36
v_exp_f32 v37, -v37
v_add_f32 v36, 1.0, v36
v_add_f32 v37, 1.0, v37
v_rcp_f32 v36, v36
v_rcp_f32 v37, v37
v_mul_f32 v36, v36, v32
v_mul_f32 v37, v37, v33
v_cvt_pk_bf16_f32 v32, v36, v37
v_lshlrev_b32 v36, 16, v32
v_and_b32 v37, s50, v32
v_mul_f32 v36, v36, v34
v_mul_f32 v37, v37, v35
v_cvt_pk_bf16_f32 v32, v36, v37
s_nop 1
v_mov_b32_dpp v33, v32 row_ror:8 row_mask:0xf bank_mask:0xf
v_cndmask_b32 v20, v32, 0, s[32:33]
v_cndmask_b32 v23, 0, v32, s[32:33]
v_cndmask_b32 v21, v33, 0, s[32:33]
v_cndmask_b32 v22, 0, v33, s[32:33]
s_mov_b32 s34, 1
s_sub_u32 s41, s3, 5
s_cmp_lt_u32 s41, 0
s_cbranch_scc1 L_dn0
s_waitcnt vmcnt(0)
L_dn0:
s_waitcnt vmcnt(1)
v_perm_b32 v64, v232, v228, s55
v_perm_b32 v65, v240, v236, s55
v_perm_b32 v66, v232, v228, s56
v_perm_b32 v67, v240, v236, s56
v_perm_b32 v68, v233, v229, s55
v_perm_b32 v69, v241, v237, s55
v_perm_b32 v70, v233, v229, s56
v_perm_b32 v71, v241, v237, s56
v_perm_b32 v72, v234, v230, s55
v_perm_b32 v73, v242, v238, s55
v_perm_b32 v74, v234, v230, s56
v_perm_b32 v75, v242, v238, s56
v_perm_b32 v76, v235, v231, s55
v_perm_b32 v77, v243, v239, s55
v_perm_b32 v78, v235, v231, s56
v_perm_b32 v79, v243, v239, s56
v_mfma_f32_16x16x32_bf16 v[32:35], v[64:67], v[20:23], 0
v_mfma_f32_16x16x32_bf16 v[36:39], v[68:71], v[20:23], 0
v_mfma_f32_16x16x32_bf16 v[40:43], v[72:75], v[20:23], 0
v_mfma_f32_16x16x32_bf16 v[44:47], v[76:79], v[20:23], 0
s_nop 5
v_permlane32_swap_b32 v32, v36
v_permlane32_swap_b32 v33, v37
v_permlane32_swap_b32 v34, v38
v_permlane32_swap_b32 v35, v39
v_permlane32_swap_b32 v40, v44
v_permlane32_swap_b32 v41, v45
v_permlane32_swap_b32 v42, v46
v_permlane32_swap_b32 v43, v47
v_add_f32_dpp v32, v36, v32 row_shl:4 row_mask:0xf bank_mask:0x5
v_add_f32_dpp v33, v37, v33 row_shl:4 row_mask:0xf bank_mask:0x5
v_add_f32_dpp v34, v38, v34 row_shl:4 row_mask:0xf bank_mask:0x5
v_add_f32_dpp v35, v39, v35 row_shl:4 row_mask:0xf bank_mask:0x5
v_add_f32_dpp v32, v40, v44 row_shr:4 row_mask:0xf bank_mask:0xa
v_add_f32_dpp v33, v41, v45 row_shr:4 row_mask:0xf bank_mask:0xa
v_add_f32_dpp v34, v42, v46 row_shr:4 row_mask:0xf bank_mask:0xa
v_add_f32_dpp v35, v43, v47 row_shr:4 row_mask:0xf bank_mask:0xa
ds_write_b128 v18, v[32:35] offset:21888
v_lshrrev_b32 v30, 5, v1
v_lshlrev_b32 v30, 6, v30
v_and_b32 v31, 0x30, v5
v_add_u32 v30, v30, v31
s_lshr_b32 s38, s3, 1
s_mul_i32 s38, s38, 147456
s_and_b32 s41, s3, 1
s_lshl_b32 s41, s41, 13
s_add_u32 s38, s38, s41
s_lshl_b32 s41, s60, 14
s_add_u32 s38, s38, s41
s_lshl_b32 s41, s59, 7
s_add_u32 s38, s38, s41
s_add_u32 s38, s38, 589824
s_waitcnt lgkmcnt(0)
s_barrier
ds_read_b128 v[32:35], v4 offset:21888
s_waitcnt lgkmcnt(0)
v_add_f32_dpp v32, v32, v32 quad_perm:[1,0,3,2] row_mask:0xf bank_mask:0xf
v_add_f32_dpp v33, v33, v33 quad_perm:[1,0,3,2] row_mask:0xf bank_mask:0xf
v_add_f32_dpp v34, v34, v34 quad_perm:[1,0,3,2] row_mask:0xf bank_mask:0xf
v_add_f32_dpp v35, v35, v35 quad_perm:[1,0,3,2] row_mask:0xf bank_mask:0xf
v_add_f32_dpp v32, v32, v32 quad_perm:[2,3,0,1] row_mask:0xf bank_mask:0xf
v_add_f32_dpp v33, v33, v33 quad_perm:[2,3,0,1] row_mask:0xf bank_mask:0xf
v_add_f32_dpp v34, v34, v34 quad_perm:[2,3,0,1] row_mask:0xf bank_mask:0xf
v_add_f32_dpp v35, v35, v35 quad_perm:[2,3,0,1] row_mask:0xf bank_mask:0xf
v_add_f32_dpp v32, v32, v32 row_half_mirror row_mask:0xf bank_mask:0xf
v_add_f32_dpp v33, v33, v33 row_half_mirror row_mask:0xf bank_mask:0xf
v_add_f32_dpp v34, v34, v34 row_half_mirror row_mask:0xf bank_mask:0xf
v_add_f32_dpp v35, v35, v35 row_half_mirror row_mask:0xf bank_mask:0xf
H4:
s_cbranch_execz H5
v_and_or_b32 v32, v32, s51, v8
v_and_or_b32 v33, v33, s51, v9
v_and_or_b32 v34, v34, s51, v10
v_and_or_b32 v35, v35, s51, v11
s_mov_b64 exec, s[42:43]
buffer_store_dwordx4 v[32:35], v30, s[24:27], s38 offen sc1
s_mov_b64 exec, -1
s_branch L_fin
L_ctail:
s_lshl_b32 s66, s62, 14
s_lshr_b32 s41, s3, 2
s_lshl_b32 s67, s41, 11
s_add_u32 s66, s66, s67
s_and_b32 s67, s3, 3
s_lshl_b32 s67, s67, 7
s_add_u32 s66, s66, s67
s_add_u32 s66, s66, 262144
s_mov_b32 s65, 200000
s_mov_b32 s34, 3
s_waitcnt vmcnt(0)
v_perm_b32 v64, v232, v228, s55
v_perm_b32 v65, v240, v236, s55
v_perm_b32 v66, v232, v228, s56
v_perm_b32 v67, v240, v236, s56
v_perm_b32 v68, v233, v229, s55
v_perm_b32 v69, v241, v237, s55
v_perm_b32 v70, v233, v229, s56
v_perm_b32 v71, v241, v237, s56
v_perm_b32 v72, v234, v230, s55
v_perm_b32 v73, v242, v238, s55
v_perm_b32 v74, v234, v230, s56
v_perm_b32 v75, v242, v238, s56
v_perm_b32 v76, v235, v231, s55
v_perm_b32 v77, v243, v239, s55
v_perm_b32 v78, v235, v231, s56
v_perm_b32 v79, v243, v239, s56
v_perm_b32 v80, v196, v192, s55
v_perm_b32 v81, v204, v200, s55
v_perm_b32 v82, v196, v192, s56
v_perm_b32 v83, v204, v200, s56
v_perm_b32 v84, v197, v193, s55
v_perm_b32 v85, v205, v201, s55
v_perm_b32 v86, v197, v193, s56
v_perm_b32 v87, v205, v201, s56
v_perm_b32 v88, v198, v194, s55
v_perm_b32 v89, v206, v202, s55
v_perm_b32 v90, v198, v194, s56
v_perm_b32 v91, v206, v202, s56
v_perm_b32 v92, v199, v195, s55
v_perm_b32 v93, v207, v203, s55
v_perm_b32 v94, v199, v195, s56
v_perm_b32 v95, v207, v203, s56
v_perm_b32 v96, v212, v208, s55
v_perm_b32 v97, v220, v216, s55
v_perm_b32 v98, v212, v208, s56
v_perm_b32 v99, v220, v216, s56
v_perm_b32 v100, v213, v209, s55
v_perm_b32 v101, v221, v217, s55
v_perm_b32 v102, v213, v209, s56
v_perm_b32 v103, v221, v217, s56
v_perm_b32 v104, v214, v210, s55
v_perm_b32 v105, v222, v218, s55
v_perm_b32 v106, v214, v210, s56
v_perm_b32 v107, v222, v218, s56
v_perm_b32 v108, v215, v211, s55
v_perm_b32 v109, v223, v219, s55
v_perm_b32 v110, v215, v211, s56
v_perm_b32 v111, v223, v219, s56
s_lshl_b32 s67, s62, 9
s_lshr_b32 s41, s3, 2
s_lshl_b32 s41, s41, 4
s_add_u32 s67, s67, s41
s_add_u32 s67, s67, 524288
v_and_b32 v19, 3, v1
v_lshlrev_b32 v19, 7, v19
v_bfe_u32 v20, v1, 2, 2
v_lshl_add_u32 v19, v20, 5, v19
v_lshl_add_u32 v16, v20, 9, v7
v_xor_b32 v17, 0x200, v16
v_lshrrev_b32 v24, 5, v1
v_lshlrev_b32 v24, 11, v24
v_and_b32 v25, 31, v1
v_lshl_add_u32 v24, v25, 4, v24
v_and_b32 v25, 3, v1
v_lshlrev_b32 v25, 4, v25
s_lshr_b32 s41, s3, 1
s_and_b32 s68, s3, 1
s_lshl_b32 s66, s62, 14
s_lshl_b32 s67, s41, 12
s_add_u32 s66, s66, s67
s_lshl_b32 s67, s68, 10
s_add_u32 s66, s66, s67
s_add_u32 s66, s66, 262144
s_mul_i32 s39, s41, 4160
s_add_u32 s39, s39, s67
v_add_u32 v26, s39, v24
s_lshl_b32 s67, s41, 7
s_lshl_b32 s68, s68, 6
s_add_u32 s67, s67, s68
v_add_u32 v27, s67, v25
s_lshl_b32 s68, s62, 9
s_add_u32 s67, s67, s68
s_add_u32 s67, s67, 524288
v_and_b32 v21, 3, v1
v_lshl_add_u32 v16, v21, 6, v16
s_lshr_b32 s41, s3, 2
s_lshl_b32 s68, s41, 11
s_and_b32 s39, s3, 3
s_lshl_b32 s39, s39, 7
s_add_u32 s68, s68, s39
v_xor_b32 v17, 0x200, v16
v_add_u32 v16, s68, v16
v_add_u32 v17, s68, v17
s_lshl_b32 s41, s41, 4
v_add_u32 v19, s41, v19
L_ochk:
buffer_load_dwordx4 v[32:35], v25, s[24:27], s67 offen sc1
buffer_load_dwordx4 v[36:39], v24, s[24:27], s66 offen sc1
buffer_load_dwordx4 v[40:43], v24, s[24:27], s66 offen offset:512 sc1
s_waitcnt vmcnt(0)
v_perm_b32 v20, v33, v32, s57
v_perm_b32 v21, v35, v34, s58
v_or_b32 v20, v20, v21
v_cmp_ne_u32 vcc, s48, v20
v_perm_b32 v22, v37, v36, s57
v_perm_b32 v23, v39, v38, s58
v_or_b32 v22, v22, v23
v_cmp_ne_u32 s[52:53], s48, v22
s_nop 0
s_or_b64 vcc, vcc, s[52:53]
v_perm_b32 v20, v41, v40, s57
v_perm_b32 v21, v43, v42, s58
v_or_b32 v20, v20, v21
v_cmp_ne_u32 s[52:53], s48, v20
s_nop 0
s_or_b64 vcc, vcc, s[52:53]
s_cbranch_vccz L_ook
s_sub_u32 s65, s65, 1
s_cbranch_scc0 L_ochk
L_ook:
ds_write_b128 v26, v[36:39] offset:48000
ds_write_b128 v26, v[40:43] offset:48512
ds_write_b64 v27, v[32:33] offset:64640
s_waitcnt lgkmcnt(0)
s_barrier
ds_read_b64 v[32:33], v19 offset:64640
ds_read_b128 v[36:39], v16 offset:48000
ds_read_b128 v[40:43], v17 offset:48000
s_waitcnt lgkmcnt(2)
v_and_b32 v32, s51, v32
v_and_b32 v33, s51, v33
s_nop 0
v_max_f32_dpp v24, v32, v32 row_ror:8 row_mask:0xf bank_mask:0xf
s_nop 1
v_max_f32_dpp v24, v24, v24 row_ror:4 row_mask:0xf bank_mask:0xf
v_sub_f32 v24, v32, v24
v_exp_f32 v24, v24
H5:
s_cbranch_execz L_hret
v_mul_f32 v25, v24, v33
s_nop 1
v_add_f32_dpp v25, v25, v25 row_ror:8 row_mask:0xf bank_mask:0xf
s_nop 1
v_add_f32_dpp v25, v25, v25 row_ror:4 row_mask:0xf bank_mask:0xf
v_rcp_f32 v25, v25
s_nop 0
v_mul_f32 v24, v24, v25
s_nop 1
v_mov_b32_dpp v25, v24 row_shl:4 row_mask:0xf bank_mask:0x5
v_mov_b32_dpp v25, v24 row_shr:4 row_mask:0xf bank_mask:0xa
s_waitcnt lgkmcnt(0)
v_and_b32 v36, s51, v36
v_and_b32 v37, s51, v37
v_and_b32 v38, s51, v38
v_and_b32 v39, s51, v39
v_and_b32 v40, s51, v40
v_and_b32 v41, s51, v41
v_and_b32 v42, s51, v42
v_and_b32 v43, s51, v43
v_mul_f32 v32, v24, v36
v_mul_f32 v33, v24, v37
v_mul_f32 v34, v24, v38
v_mul_f32 v35, v24, v39
v_fmac_f32 v32, v25, v40
v_fmac_f32 v33, v25, v41
v_fmac_f32 v34, v25, v42
v_fmac_f32 v35, v25, v43
v_add_f32_dpp v32, v32, v32 row_ror:8 row_mask:0xf bank_mask:0xf
v_add_f32_dpp v33, v33, v33 row_ror:8 row_mask:0xf bank_mask:0xf
v_add_f32_dpp v34, v34, v34 row_ror:8 row_mask:0xf bank_mask:0xf
v_add_f32_dpp v35, v35, v35 row_ror:8 row_mask:0xf bank_mask:0xf
v_cvt_pk_bf16_f32 v20, v32, v33
v_cvt_pk_bf16_f32 v21, v34, v35
v_cndmask_b32 v22, 0, v20, s[32:33]
v_cndmask_b32 v23, 0, v21, s[32:33]
v_cndmask_b32 v20, v20, 0, s[32:33]
v_cndmask_b32 v21, v21, 0, s[32:33]
s_nop 1
v_mfma_f32_16x16x32_bf16 v[32:35], v[64:67], v[20:23], 0
v_mfma_f32_16x16x32_bf16 v[36:39], v[68:71], v[20:23], 0
v_mfma_f32_16x16x32_bf16 v[40:43], v[72:75], v[20:23], 0
v_mfma_f32_16x16x32_bf16 v[44:47], v[76:79], v[20:23], 0
v_mfma_f32_16x16x32_bf16 v[48:51], v[80:83], v[20:23], 0
v_mfma_f32_16x16x32_bf16 v[52:55], v[84:87], v[20:23], 0
v_mfma_f32_16x16x32_bf16 v[56:59], v[88:91], v[20:23], 0
v_mfma_f32_16x16x32_bf16 v[60:63], v[92:95], v[20:23], 0
v_mfma_f32_16x16x32_bf16 v[112:115], v[96:99], v[20:23], 0
v_mfma_f32_16x16x32_bf16 v[116:119], v[100:103], v[20:23], 0
v_mfma_f32_16x16x32_bf16 v[120:123], v[104:107], v[20:23], 0
v_mfma_f32_16x16x32_bf16 v[124:127], v[108:111], v[20:23], 0
v_permlane32_swap_b32 v32, v36
v_permlane32_swap_b32 v33, v37
v_permlane32_swap_b32 v34, v38
v_permlane32_swap_b32 v35, v39
v_permlane32_swap_b32 v40, v44
v_permlane32_swap_b32 v41, v45
v_permlane32_swap_b32 v42, v46
v_permlane32_swap_b32 v43, v47
v_add_f32_dpp v32, v36, v32 row_shl:4 row_mask:0xf bank_mask:0x5
v_add_f32_dpp v33, v37, v33 row_shl:4 row_mask:0xf bank_mask:0x5
v_add_f32_dpp v34, v38, v34 row_shl:4 row_mask:0xf bank_mask:0x5
v_add_f32_dpp v35, v39, v35 row_shl:4 row_mask:0xf bank_mask:0x5
v_add_f32_dpp v32, v40, v44 row_shr:4 row_mask:0xf bank_mask:0xa
v_add_f32_dpp v33, v41, v45 row_shr:4 row_mask:0xf bank_mask:0xa
v_add_f32_dpp v34, v42, v46 row_shr:4 row_mask:0xf bank_mask:0xa
v_add_f32_dpp v35, v43, v47 row_shr:4 row_mask:0xf bank_mask:0xa
ds_write_b128 v18, v[32:35] offset:21888
v_permlane32_swap_b32 v48, v52
v_permlane32_swap_b32 v49, v53
v_permlane32_swap_b32 v50, v54
v_permlane32_swap_b32 v51, v55
v_permlane32_swap_b32 v56, v60
v_permlane32_swap_b32 v57, v61
v_permlane32_swap_b32 v58, v62
v_permlane32_swap_b32 v59, v63
v_add_f32_dpp v48, v52, v48 row_shl:4 row_mask:0xf bank_mask:0x5
v_add_f32_dpp v49, v53, v49 row_shl:4 row_mask:0xf bank_mask:0x5
v_add_f32_dpp v50, v54, v50 row_shl:4 row_mask:0xf bank_mask:0x5
v_add_f32_dpp v51, v55, v51 row_shl:4 row_mask:0xf bank_mask:0x5
v_add_f32_dpp v48, v56, v60 row_shr:4 row_mask:0xf bank_mask:0xa
v_add_f32_dpp v49, v57, v61 row_shr:4 row_mask:0xf bank_mask:0xa
v_add_f32_dpp v50, v58, v62 row_shr:4 row_mask:0xf bank_mask:0xa
v_add_f32_dpp v51, v59, v63 row_shr:4 row_mask:0xf bank_mask:0xa
ds_write_b128 v18, v[48:51] offset:30592
v_permlane32_swap_b32 v112, v116
v_permlane32_swap_b32 v113, v117
v_permlane32_swap_b32 v114, v118
v_permlane32_swap_b32 v115, v119
v_permlane32_swap_b32 v120, v124
v_permlane32_swap_b32 v121, v125
v_permlane32_swap_b32 v122, v126
v_permlane32_swap_b32 v123, v127
v_add_f32_dpp v112, v116, v112 row_shl:4 row_mask:0xf bank_mask:0x5
v_add_f32_dpp v113, v117, v113 row_shl:4 row_mask:0xf bank_mask:0x5
v_add_f32_dpp v114, v118, v114 row_shl:4 row_mask:0xf bank_mask:0x5
v_add_f32_dpp v115, v119, v115 row_shl:4 row_mask:0xf bank_mask:0x5
v_add_f32_dpp v112, v120, v124 row_shr:4 row_mask:0xf bank_mask:0xa
v_add_f32_dpp v113, v121, v125 row_shr:4 row_mask:0xf bank_mask:0xa
v_add_f32_dpp v114, v122, v126 row_shr:4 row_mask:0xf bank_mask:0xa
v_add_f32_dpp v115, v123, v127 row_shr:4 row_mask:0xf bank_mask:0xa
ds_write_b128 v18, v[112:115] offset:39296
L_s3red:
s_waitcnt lgkmcnt(0)
s_barrier
s_cmp_ge_u32 s3, s34
s_cbranch_scc1 L_fin
ds_read_b128 v[32:35], v29 offset:21888
ds_read_b128 v[36:39], v29 offset:22976
ds_read_b128 v[40:43], v29 offset:24064
ds_read_b128 v[44:47], v29 offset:25152
ds_read_b128 v[48:51], v29 offset:26240
ds_read_b128 v[52:55], v29 offset:27328
ds_read_b128 v[56:59], v29 offset:28416
ds_read_b128 v[60:63], v29 offset:29504
s_waitcnt lgkmcnt(4)
v_pk_add_f32 v[32:33], v[32:33], v[36:37]
v_pk_add_f32 v[34:35], v[34:35], v[38:39]
v_pk_add_f32 v[32:33], v[32:33], v[40:41]
v_pk_add_f32 v[34:35], v[34:35], v[42:43]
v_pk_add_f32 v[32:33], v[32:33], v[44:45]
v_pk_add_f32 v[34:35], v[34:35], v[46:47]
s_waitcnt lgkmcnt(0)
v_pk_add_f32 v[32:33], v[32:33], v[48:49]
v_pk_add_f32 v[34:35], v[34:35], v[50:51]
v_pk_add_f32 v[32:33], v[32:33], v[52:53]
v_pk_add_f32 v[34:35], v[34:35], v[54:55]
v_pk_add_f32 v[32:33], v[32:33], v[56:57]
v_pk_add_f32 v[34:35], v[34:35], v[58:59]
v_pk_add_f32 v[32:33], v[32:33], v[60:61]
v_pk_add_f32 v[34:35], v[34:35], v[62:63]
v_and_or_b32 v32, v32, s51, v8
v_and_or_b32 v33, v33, s51, v9
v_and_or_b32 v34, v34, s51, v10
v_and_or_b32 v35, v35, s51, v11
buffer_store_dwordx4 v[32:35], v28, s[24:27], s40 offen sc1
s_branch L_fin
L_final:
s_cmp_ge_u32 s2, 36
s_cbranch_scc1 L_epoch
H6:
s_cbranch_execz H7
s_and_b32 s64, s3, 3
s_lshl_b32 s41, s64, 8
v_lshl_add_u32 v30, v1, 2, s41
v_mov_b32 v31, 0
ds_write_b32 v30, v31 offset:4736
s_waitcnt lgkmcnt(0)
s_barrier
s_mul_i32 s66, s2, 57
s_lshr_b32 s66, s66, 9
s_mul_i32 s67, s66, 9
s_sub_u32 s67, s2, s67
s_mul_i32 s66, s66, 1152
s_lshl_b32 s67, s67, 7
s_add_u32 s66, s66, s67
s_lshr_b32 s67, s64, 1
s_lshl_b32 s67, s67, 6
s_add_u32 s66, s66, s67
s_and_b32 s67, s64, 1
s_lshl_b32 s67, s67, 3
s_add_u32 s66, s66, s67
v_and_b32 v20, 3, v1
v_lshlrev_b32 v21, 4, v20
v_lshrrev_b32 v22, 4, v1
v_lshl_add_u32 v21, v22, 1, v21
buffer_load_ushort v19, v21, s[4:7], s66 offen
v_and_b32 v23, 15, v1
v_lshlrev_b32 v24, 7, v23
v_lshl_add_u32 v24, v22, 4, v24
v_and_b32 v25, 1, v1
v_lshlrev_b32 v25, 7, v25
v_lshl_add_u32 v25, v22, 4, v25
v_add_u32 v25, 2048, v25
s_lshl_b32 s67, s2, 2
s_add_u32 s67, s67, s64
s_lshl_b32 s67, s67, 12
s_and_b32 s68, s64, 1
s_mul_i32 s68, s68, 4032
s_sub_u32 s67, s67, s68
s_add_u32 s67, s67, 589824
v_cmp_gt_u32 s[60:61], 2, v23
v_cmp_eq_u32 s[62:63], 1, v20
v_cmp_eq_u32 s[44:45], 2, v20
v_cmp_eq_u32 s[46:47], 3, v20
s_mov_b32 s40, 0xaaaaaaaa
s_mov_b32 s41, 0xaaaaaaaa
s_mov_b32 s42, 0xcccccccc
s_mov_b32 s43, 0xcccccccc
s_mov_b32 s65, 200000
s_cmp_lt_u32 s3, 4
s_cbranch_scc1 L_sw
L_gchk:
buffer_load_dwordx4 v[36:39], v24, s[24:27], s67 offen offset:2048 sc1
buffer_load_dwordx4 v[40:43], v25, s[24:27], s67 offen offset:2048 sc1
s_waitcnt vmcnt(0)
v_perm_b32 v26, v37, v36, s57
v_perm_b32 v27, v39, v38, s58
v_or_b32 v26, v26, v27
v_cmp_ne_u32 vcc, s48, v26
v_perm_b32 v28, v41, v40, s57
v_perm_b32 v29, v43, v42, s58
v_or_b32 v28, v28, v29
v_cmp_ne_u32 s[52:53], s48, v28
s_nop 0
s_or_b64 vcc, vcc, s[52:53]
s_cbranch_vccz L_gok
s_sub_u32 s65, s65, 1
s_cbranch_scc0 L_gchk
L_gok:
v_and_b32 v36, s51, v36
v_and_b32 v37, s51, v37
v_and_b32 v38, s51, v38
v_and_b32 v39, s51, v39
v_and_b32 v40, s51, v40
v_and_b32 v41, s51, v41
v_and_b32 v42, s51, v42
v_and_b32 v43, s51, v43
v_cndmask_b32 v40, 0, v40, s[60:61]
v_cndmask_b32 v41, 0, v41, s[60:61]
v_cndmask_b32 v42, 0, v42, s[60:61]
v_cndmask_b32 v43, 0, v43, s[60:61]
v_add_f32 v36, v36, v40
v_add_f32 v37, v37, v41
v_add_f32 v38, v38, v42
v_add_f32 v39, v39, v43
v_add_f32_dpp v36, v36, v36 row_ror:8 row_mask:0xf bank_mask:0xf
v_add_f32_dpp v37, v37, v37 row_ror:8 row_mask:0xf bank_mask:0xf
v_add_f32_dpp v38, v38, v38 row_ror:8 row_mask:0xf bank_mask:0xf
v_add_f32_dpp v39, v39, v39 row_ror:8 row_mask:0xf bank_mask:0xf
v_add_f32_dpp v36, v36, v36 row_ror:4 row_mask:0xf bank_mask:0xf
v_add_f32_dpp v37, v37, v37 row_ror:4 row_mask:0xf bank_mask:0xf
v_add_f32_dpp v38, v38, v38 row_ror:4 row_mask:0xf bank_mask:0xf
v_add_f32_dpp v39, v39, v39 row_ror:4 row_mask:0xf bank_mask:0xf
v_add_f32_dpp v36, v36, v36 row_ror:2 row_mask:0xf bank_mask:0xf
v_add_f32_dpp v37, v37, v37 row_ror:2 row_mask:0xf bank_mask:0xf
v_add_f32_dpp v38, v38, v38 row_ror:2 row_mask:0xf bank_mask:0xf
v_add_f32_dpp v39, v39, v39 row_ror:2 row_mask:0xf bank_mask:0xf
v_add_f32_dpp v36, v36, v36 row_ror:1 row_mask:0xf bank_mask:0xf
v_add_f32_dpp v37, v37, v37 row_ror:1 row_mask:0xf bank_mask:0xf
v_add_f32_dpp v38, v38, v38 row_ror:1 row_mask:0xf bank_mask:0xf
v_add_f32_dpp v39, v39, v39 row_ror:1 row_mask:0xf bank_mask:0xf
v_cndmask_b32 v36, v36, v37, s[62:63]
v_cndmask_b32 v36, v36, v38, s[44:45]
v_cndmask_b32 v36, v36, v39, s[46:47]
v_cvt_pk_bf16_f32 v36, v36, v36
v_and_b32 v36, s50, v36
v_mul_f32 v37, 0xbfb8aa3b, v36
v_exp_f32 v37, v37
v_lshlrev_b32 v18, 16, v19
v_add_f32 v37, 1.0, v37
v_rcp_f32 v37, v37
v_cmp_gt_u32 s[60:61], 4, v23
v_mul_f32 v37, v37, v36
v_cvt_pk_bf16_f32 v37, v37, v37
v_and_b32 v37, s50, v37
v_or_b32 v37, 1, v37
ds_write_b32 v30, v37 offset:4736
s_branch L_fin
L_sw:
buffer_load_dwordx4 v[32:35], v24, s[24:27], s67 offen sc1
v_cmp_gt_u32 s[60:61], 4, v23
L_fchk:
s_waitcnt vmcnt(0)
v_perm_b32 v26, v33, v32, s57
v_perm_b32 v27, v35, v34, s58
v_or_b32 v26, v26, v27
v_cmp_ne_u32 vcc, s48, v26
s_nop 0
s_cbranch_vccz L_fok
buffer_load_dwordx4 v[32:35], v24, s[24:27], s67 offen sc1
s_sub_u32 s65, s65, 1
s_cbranch_scc0 L_fchk
L_fok:
ds_read_b32 v37, v30 offset:4736
v_lshlrev_b32 v18, 16, v19
v_and_b32 v32, s51, v32
v_and_b32 v33, s51, v33
v_and_b32 v34, s51, v34
v_and_b32 v35, s51, v35
v_add_f32_dpp v32, v32, v32 row_ror:8 row_mask:0xf bank_mask:0xf
v_add_f32_dpp v33, v33, v33 row_ror:8 row_mask:0xf bank_mask:0xf
v_add_f32_dpp v34, v34, v34 row_ror:8 row_mask:0xf bank_mask:0xf
v_add_f32_dpp v35, v35, v35 row_ror:8 row_mask:0xf bank_mask:0xf
v_add_f32_dpp v32, v32, v32 row_ror:4 row_mask:0xf bank_mask:0xf
v_add_f32_dpp v33, v33, v33 row_ror:4 row_mask:0xf bank_mask:0xf
v_add_f32_dpp v34, v34, v34 row_ror:4 row_mask:0xf bank_mask:0xf
v_add_f32_dpp v35, v35, v35 row_ror:4 row_mask:0xf bank_mask:0xf
v_add_f32_dpp v32, v32, v32 quad_perm:[1,0,3,2] row_mask:0xf bank_mask:0xf
v_add_f32_dpp v33, v33, v33 quad_perm:[1,0,3,2] row_mask:0xf bank_mask:0xf
v_add_f32_dpp v34, v34, v34 quad_perm:[1,0,3,2] row_mask:0xf bank_mask:0xf
v_add_f32_dpp v35, v35, v35 quad_perm:[1,0,3,2] row_mask:0xf bank_mask:0xf
v_cndmask_b32 v32, v32, v33, s[40:41]
v_cndmask_b32 v34, v34, v35, s[40:41]
H7:
s_cbranch_execz L_hret
v_add_f32_dpp v32, v32, v32 quad_perm:[2,3,0,1] row_mask:0xf bank_mask:0xf
v_add_f32_dpp v34, v34, v34 quad_perm:[2,3,0,1] row_mask:0xf bank_mask:0xf
v_cndmask_b32 v32, v32, v34, s[42:43]
v_cvt_pk_bf16_f32 v32, v32, v32
v_and_b32 v32, s50, v32
L_lw:
s_waitcnt lgkmcnt(0)
v_and_b32 v38, 1, v37
v_cmp_eq_u32 vcc, 0, v38
s_nop 0
s_cbranch_vccz L_lok
ds_read_b32 v37, v30 offset:4736
s_sub_u32 s65, s65, 1
s_cbranch_scc0 L_lw
L_lok:
v_and_b32 v37, s50, v37
v_mul_f32 v32, v32, v37
v_cvt_pk_bf16_f32 v32, v32, v32
v_and_b32 v32, s50, v32
v_add_f32 v32, v32, v18
v_cvt_pk_bf16_f32 v32, v32, v32
s_mov_b64 exec, s[60:61]
buffer_store_short v32, v21, s[28:31], s66 offen
s_mov_b64 exec, -1
s_branch L_fin
L_epoch:
s_cmp_lg_u32 s2, 45
s_cbranch_scc1 L_fin
s_cmp_lg_u32 s3, 5
s_cbranch_scc1 L_fin
v_mov_b32 v20, 0
v_lshlrev_b32 v24, 5, v1
s_mov_b32 s65, 200000
s_mov_b32 s44, 524288
s_mov_b32 s45, 526336
s_mov_b32 s46, 528384
s_mov_b32 s47, 530432
L_echk:
buffer_load_dwordx4 v[32:35], v24, s[24:27], s44 offen sc1
buffer_load_dwordx4 v[36:39], v24, s[24:27], s45 offen sc1
buffer_load_dwordx4 v[40:43], v24, s[24:27], s46 offen sc1
buffer_load_dwordx4 v[44:47], v24, s[24:27], s47 offen sc1
s_waitcnt vmcnt(0)
v_perm_b32 v26, v33, v32, s57
v_perm_b32 v27, v35, v34, s58
v_or_b32 v26, v26, v27
v_cmp_ne_u32 vcc, s48, v26
v_perm_b32 v26, v37, v36, s57
v_perm_b32 v27, v39, v38, s58
v_or_b32 v26, v26, v27
v_cmp_ne_u32 s[52:53], s48, v26
s_nop 0
s_or_b64 vcc, vcc, s[52:53]
v_perm_b32 v26, v41, v40, s57
v_perm_b32 v27, v43, v42, s58
v_or_b32 v26, v26, v27
v_cmp_ne_u32 s[52:53], s48, v26
s_nop 0
s_or_b64 vcc, vcc, s[52:53]
v_perm_b32 v26, v45, v44, s57
v_perm_b32 v27, v47, v46, s58
v_or_b32 v26, v26, v27
v_cmp_ne_u32 s[52:53], s48, v26
s_nop 0
s_or_b64 vcc, vcc, s[52:53]
s_cbranch_vccz L_eok
s_sleep 8
s_sub_u32 s65, s65, 1
s_cbranch_scc0 L_echk
L_eok:
v_mov_b32 v21, s48
s_mov_b64 exec, 1
buffer_store_dword v21, v20, s[24:27], 0 offen sc1
s_mov_b64 exec, -1
L_fin:
L_end:
s_endpgm
L_codeend:
.section .rodata,"a"
.p2align 6
.amdhsa_kernel recurrent_scan__sliding_block_cached__geglu_ffn__decode_kernel
.amdhsa_next_free_vgpr 256
.amdhsa_next_free_sgpr 102
.amdhsa_accum_offset 256
.amdhsa_group_segment_fixed_size 0
.amdhsa_kernarg_size 96
.amdhsa_user_sgpr_count 2
.amdhsa_user_sgpr_kernarg_segment_ptr 1
.amdhsa_system_sgpr_workgroup_id_x 1
.end_amdhsa_kernel
```
